```python
import torch

def _softmax(x, axis=-1):
    return torch.softmax(x, dim=axis)

def _gelu(x):
    return torch.nn.functional.gelu(x, approximate='tanh')

def _silu(x):
    return torch.nn.functional.silu(x)

def _sigmoid(x):
    return torch.sigmoid(x)

def _layernorm(x, axis=-1, eps=1e-05):
    m = x.mean(dim=axis, keepdim=True)
    v = x.var(dim=axis, keepdim=True, unbiased=False)
    return (x - m) / torch.sqrt(v + eps)

def _scatter_add(tgt, idx, src, axis=0):
    return tgt.clone().index_add_(axis, idx, src)

def _segment_sum(src, seg, n):
    out = torch.zeros((n,) + src.shape[1:], dtype=src.dtype)
    return out.index_add_(0, seg, src)

def _pad(x, pw):
    flat = tuple((v for pair in reversed(pw) for v in pair))
    return torch.nn.functional.pad(x, flat)
kernel_name = 'standalone__kv_cache_quant_pre_rope_vs_post_rope__prompt'

def setup_inputs():

    _w = lambda a: (lambda t: t.to(torch.bfloat16) if t.is_floating_point() else t)(torch.as_tensor(a))
    B, Sq, Skv = (1, 2048, 2048)
    H, Dh0 = (8, 256)
    G = 64 if 64 > 0 else Dh0
    G = max(2, G // 2 * 2)
    Dh = max(G, Dh0 // G * G)
    Skv = max(Skv, Sq)
    ng = Dh // G
    bits = 8 if 8 > 1 else 4
    bits = max(2, min(8, bits))
    qmax = (1 << bits) - 1
    half = Dh // 2
    inv = 1.0 / 10000.0 ** (torch.arange(half) / max(1, half))
    ang_k = torch.arange(Skv)[:, None] * inv[None, :]
    ang_q = torch.arange(Skv - Sq, Skv)[:, None] * inv[None, :]
    kc = torch.cat([torch.cos(ang_k), torch.cos(ang_k)], dim=-1)
    ks = torch.cat([torch.sin(ang_k), torch.sin(ang_k)], dim=-1)
    qc = torch.cat([torch.cos(ang_q), torch.cos(ang_q)], dim=-1)
    qs = torch.cat([torch.sin(ang_q), torch.sin(ang_q)], dim=-1)
    qk_i = torch.randint(0, qmax + 1, (B, H, Skv, Dh)).to(torch.int32)
    qv_i = torch.randint(0, qmax + 1, (B, H, Skv, Dh)).to(torch.int32)
    ksc = torch.abs((lambda *s: torch.randn(*s, dtype=torch.bfloat16) * 0.05)(B, H, Skv, ng)) * 0.1 + 0.01
    kzp = torch.full((B, H, Skv, ng), qmax / 2.0)
    vsc = torch.abs((lambda *s: torch.randn(*s, dtype=torch.bfloat16) * 0.05)(B, H, Skv, ng)) * 0.1 + 0.01
    vzp = torch.full((B, H, Skv, ng), qmax / 2.0)
    return {'q': _w((lambda *s: torch.randn(*s, dtype=torch.bfloat16) * 0.8)(B, H, Sq, Dh) * 0.5), 'qk': _w(qk_i), 'k_scales': _w(ksc), 'k_zeros': _w(kzp), 'qv': _w(qv_i), 'v_scales': _w(vsc), 'v_zeros': _w(vzp), 'q_cos': _w(qc), 'q_sin': _w(qs), 'k_cos': _w(kc), 'k_sin': _w(ks)}

def reference(q, qk, k_scales, k_zeros, qv, v_scales, v_zeros, q_cos, q_sin, k_cos, k_sin):
    B, H, Sq, Dh = q.shape
    ng = k_scales.shape[-1]
    G = Dh // ng
    half = Dh // 2
    ks = (lambda x, n, axis: torch.repeat_interleave(x, n, dim=axis))(k_scales, G, axis=-1)
    kz = (lambda x, n, axis: torch.repeat_interleave(x, n, dim=axis))(k_zeros, G, axis=-1)
    k = ((lambda x, dt: x.to(dt))(qk, q.dtype) - kz) * ks
    vs = (lambda x, n, axis: torch.repeat_interleave(x, n, dim=axis))(v_scales, G, axis=-1)
    vz = (lambda x, n, axis: torch.repeat_interleave(x, n, dim=axis))(v_zeros, G, axis=-1)
    v = ((lambda x, dt: x.to(dt))(qv, q.dtype) - vz) * vs
    k1 = k[..., :half].clone()
    k2 = k[..., half:].clone()
    krh = torch.concatenate([-k2, k1], axis=-1)
    kr = k * k_cos[None, None, :, :] + krh * k_sin[None, None, :, :]
    q1 = q[..., :half].clone()
    q2 = q[..., half:].clone()
    qrh = torch.concatenate([-q2, q1], axis=-1)
    qr = q * q_cos[None, None, :, :] + qrh * q_sin[None, None, :, :]
    logits = torch.einsum('bhqd,bhkd->bhqk', qr, kr) * float(Dh) ** (-0.5)
    attn = _softmax(logits, axis=-1)
    out = torch.einsum('bhqk,bhkd->bhqd', attn, v)
    return out
```

```asm
; @launch grid=(256,1,1) block=(256,1,1) lds=137216
.amdgcn_target "amdgcn-amd-amdhsa--gfx950"
.text
.globl standalone__kv_cache_quant_pre_rope_vs_post_rope__prompt_kernel
.p2align 8
.type standalone__kv_cache_quant_pre_rope_vs_post_rope__prompt_kernel,@function
standalone__kv_cache_quant_pre_rope_vs_post_rope__prompt_kernel:
s_cmp_ge_u32 s2, 256
s_cbranch_scc1 La_done
s_load_dwordx2 s[8:9], s[0:1], 104
v_lshrrev_b32 v11, 6, v0
v_and_b32 v0, 63, v0
v_lshrrev_b32 v14, 4, v0
v_and_b32 v15, 15, v0
v_readfirstlane_b32 s64, v11
s_mov_b32 s10, 17825792
s_mov_b32 s11, 0x00020000
s_mov_b32 s5, 84148480
s_mov_b32 s6, 117834498
s_mov_b32 s3, 0
s_cmp_lt_u32 s2, 48
s_cbranch_scc1 Lp_start
s_cmp_eq_u32 s64, 0
s_cbranch_scc1 La_w0role
s_bfe_u32 s40, s2, 196611
s_cmp_lg_u32 s40, 7
s_cbranch_scc1 La_att
s_getpc_b64 s[40:41]
La_pc:
s_sub_u32 s40, s40, La_pc-standalone__kv_cache_quant_pre_rope_vs_post_rope__prompt_kernel
s_subb_u32 s41, s41, 0
s_sub_u32 s42, s64, 1
s_lshl_b32 s42, s42, 13
v_lshlrev_b32 v240, 7, v0
v_add_u32 v240, s42, v240
v_min_u32 v240, La_end-standalone__kv_cache_quant_pre_rope_vs_post_rope__prompt_kernel-4, v240
v_mov_b32 v241, s41
v_add_co_u32 v240, vcc, s40, v240
s_nop 1
v_addc_co_u32 v241, vcc, 0, v241, vcc
global_load_dword v242, v[240:241], off
s_branch La_att
La_w0role:
s_cmp_ge_u32 s2, 240
s_cbranch_scc1 La_att
s_mov_b32 s3, 1
Lp_start:
s_load_dwordx2 s[12:13], s[0:1], 8
s_load_dwordx2 s[36:37], s[0:1], 72
s_load_dwordx2 s[40:41], s[0:1], 80
s_load_dwordx2 s[16:17], s[0:1], 16
s_load_dwordx2 s[20:21], s[0:1], 24
s_load_dwordx2 s[24:25], s[0:1], 32
s_load_dwordx2 s[28:29], s[0:1], 40
s_load_dwordx2 s[32:33], s[0:1], 48
s_mul_i32 s45, s64, 48
s_add_u32 s45, s45, s2
s_add_u32 s68, s45, 256
s_add_u32 s45, s45, 192
s_sub_u32 s67, s2, 48
s_cmp_eq_u32 s3, 0
s_cselect_b32 s45, s45, s67
s_lshr_b32 s44, s45, 6
s_and_b32 s45, s45, 63
v_lshlrev_b32 v1, 11, v14
v_lshl_add_u32 v1, v15, 4, v1
v_lshlrev_b32 v2, 10, v14
v_lshl_add_u32 v2, v15, 3, v2
v_bfe_u32 v3, v0, 3, 2
v_lshlrev_b32 v3, 14, v3
v_and_b32 v13, 7, v0
v_lshl_add_u32 v3, v13, 3, v3
v_lshlrev_b32 v13, 3, v14
v_lshlrev_b32 v19, 4, v14
v_lshlrev_b32 v4, 12, v14
v_lshl_add_u32 v4, v15, 4, v4
v_lshlrev_b32 v5, 5, v14
v_lshlrev_b32 v6, 4, v0
v_and_b32 v5, 31, v0
v_lshlrev_b32 v5, 3, v5
v_mov_b32 v18, 0
v_mov_b32 v17, 0
s_mov_b32 s14, 16777216
s_mov_b32 s15, 0x00020000
s_mov_b32 s38, 1048576
s_mov_b32 s39, 0x00020000
s_mov_b32 s42, 1048576
s_mov_b32 s43, 0x00020000
s_mov_b32 s18, 131072
s_mov_b32 s19, 0x00020000
s_mov_b32 s22, 131072
s_mov_b32 s23, 0x00020000
s_mov_b32 s26, 16777216
s_mov_b32 s27, 0x00020000
s_mov_b32 s30, 131072
s_mov_b32 s31, 0x00020000
s_mov_b32 s34, 131072
s_mov_b32 s35, 0x00020000
s_mov_b32 s4, 1035512379
s_mov_b32 s46, 17072128
s_waitcnt lgkmcnt(0)
s_add_u32 s62, s8, 16777216
s_addc_u32 s63, s9, 0
s_load_dword s65, s[62:63], 299008
s_mov_b32 s74, 0
s_cmp_lg_u32 s3, 0
s_cbranch_scc1 Lp_first
s_mov_b32 s74, 1
s_cmp_lt_u32 s64, 1
s_cbranch_scc1 Lp_first
s_mov_b32 s74, 0
s_barrier
s_branch Lp_first
Lp_next:
s_cmp_eq_u32 s3, 0
s_cbranch_scc1 Lp_next0
s_mov_b32 s47, s46
s_waitcnt vmcnt(0) lgkmcnt(0)
s_mul_i32 s66, s65, 0x9E3779B1
s_add_u32 s66, s66, 0x7F4A7C15
v_mov_b32 v17, s66
s_mov_b64 exec, 1
buffer_store_dword v17, v18, s[8:11], s47 offen sc1
s_mov_b64 exec, -1
s_add_u32 s67, s67, 208
s_cmp_ge_u32 s67, 192
s_cbranch_scc1 La_att
s_lshr_b32 s44, s67, 6
s_and_b32 s45, s67, 63
s_mov_b32 s46, 17072128
s_branch Lp_first
Lp_next0:
s_add_u32 s44, s44, 3
s_mov_b32 s47, s46
Lp_first:
s_mov_b32 s47, s46
s_cmp_ge_u32 s44, 32
s_cbranch_scc1 Lp_end
s_mov_b32 s48, s44
s_cmp_lt_u32 s44, 3
s_cbranch_scc1 Lp_k
s_sub_u32 s48, s44, 16
s_cmp_ge_u32 s44, 29
s_cbranch_scc1 Lp_v
s_sub_u32 s48, s44, 3
s_lshr_b32 s48, s48, 1
s_bitcmp1_b32 s44, 0
s_cbranch_scc1 Lp_v
s_add_u32 s48, s48, 3
Lp_k:
s_and_b32 s49, s45, 15
s_bfe_u32 s50, s45, 0x10004
s_lshr_b32 s52, s45, 5
s_lshl_b32 s51, s48, 7
s_lshl_b32 s57, s49, 3
s_add_u32 s51, s51, s57
s_lshl_b32 s58, s52, 13
s_add_u32 s58, s58, s51
s_lshl_b32 s53, s58, 10
s_lshl_b32 s57, s50, 8
s_add_u32 s53, s53, s57
s_add_u32 s54, s53, 0x200000
s_add_u32 s55, s53, 0x400000
s_add_u32 s56, s53, 0x600000
s_lshl_b32 s57, s51, 9
s_lshl_b32 s59, s50, 7
s_add_u32 s57, s57, s59
s_lshl_b32 s58, s58, 3
s_add_u32 s59, s58, 16384
s_add_u32 s60, s58, 32768
s_add_u32 s61, s58, 49152
buffer_load_dwordx2 v[46:47], v3, s[16:19], s58 offen
buffer_load_dwordx2 v[48:49], v3, s[20:23], s58 offen
buffer_load_dwordx2 v[128:129], v2, s[36:39], s57 offen offset:0
buffer_load_dwordx2 v[130:131], v2, s[36:39], s57 offen offset:256
buffer_load_dwordx2 v[132:133], v2, s[40:43], s57 offen offset:0
buffer_load_dwordx2 v[134:135], v2, s[40:43], s57 offen offset:256
buffer_load_dwordx4 v[64:67], v1, s[12:15], s53 offen offset:0
buffer_load_dwordx4 v[68:71], v1, s[12:15], s53 offen offset:512
buffer_load_dwordx4 v[72:75], v1, s[12:15], s54 offen offset:0
buffer_load_dwordx4 v[76:79], v1, s[12:15], s54 offen offset:512
buffer_load_dwordx4 v[80:83], v1, s[12:15], s55 offen offset:0
buffer_load_dwordx4 v[84:87], v1, s[12:15], s55 offen offset:512
buffer_load_dwordx4 v[88:91], v1, s[12:15], s56 offen offset:0
buffer_load_dwordx4 v[92:95], v1, s[12:15], s56 offen offset:512
s_cmp_eq_u32 s47, 17072128
s_cbranch_scc1 Lp_nf2543
s_waitcnt vmcnt(14) lgkmcnt(0)
s_mul_i32 s66, s65, 0x9E3779B1
s_add_u32 s66, s66, 0x7F4A7C15
v_mov_b32 v17, s66
s_mov_b64 exec, 1
buffer_store_dword v17, v18, s[8:11], s47 offen sc1
s_mov_b64 exec, -1
Lp_nf2543:
buffer_load_dwordx2 v[136:137], v2, s[36:39], s57 offen offset:512
buffer_load_dwordx2 v[138:139], v2, s[36:39], s57 offen offset:768
buffer_load_dwordx2 v[140:141], v2, s[40:43], s57 offen offset:512
buffer_load_dwordx2 v[142:143], v2, s[40:43], s57 offen offset:768
buffer_load_dwordx4 v[96:99], v1, s[12:15], s53 offen offset:1024
buffer_load_dwordx4 v[100:103], v1, s[12:15], s53 offen offset:1536
buffer_load_dwordx4 v[104:107], v1, s[12:15], s54 offen offset:1024
buffer_load_dwordx4 v[108:111], v1, s[12:15], s54 offen offset:1536
buffer_load_dwordx4 v[112:115], v1, s[12:15], s55 offen offset:1024
buffer_load_dwordx4 v[116:119], v1, s[12:15], s55 offen offset:1536
buffer_load_dwordx4 v[120:123], v1, s[12:15], s56 offen offset:1024
buffer_load_dwordx4 v[124:127], v1, s[12:15], s56 offen offset:1536
s_lshl_b32 s69, s52, 22
s_lshl_b32 s70, s48, 14
s_add_u32 s69, s69, s70
s_lshr_b32 s70, s49, 2
s_lshl_b32 s70, s70, 18
s_add_u32 s69, s69, s70
s_bfe_u32 s70, s49, 0x10001
s_lshl_b32 s70, s70, 13
s_add_u32 s69, s69, s70
s_and_b32 s70, s49, 1
s_lshl_b32 s70, s70, 7
s_add_u32 s69, s69, s70
s_lshl_b32 s70, s50, 11
s_add_u32 s69, s69, s70
s_add_u32 s70, s69, 4096
s_add_u32 s71, s69, 0x200000
s_add_u32 s72, s71, 4096
s_mul_i32 s7, s50, 0x02020000
s_add_u32 s7, s7, 0x01000c0c
s_lshl_b32 s46, s52, 14
s_lshl_b32 s73, s48, 10
s_add_u32 s46, s46, s73
s_and_b32 s73, s45, 31
s_lshl_b32 s73, s73, 5
s_add_u32 s46, s46, s73
s_add_u32 s46, s46, 16777216
s_cmp_lg_u32 s3, 1
s_cbranch_scc1 Lp_nb
s_barrier
s_mov_b32 s3, 2
Lp_nb:
v_lshrrev_b32 v16, 3, v15
v_bfe_u32 v44, v15, 1, 2
v_and_b32 v45, 1, v15
v_lshlrev_b32 v8, 9, v16
v_lshl_add_u32 v8, v44, 7, v8
v_lshl_add_u32 v8, v45, 3, v8
v_lshrrev_b32 v16, 1, v15
v_lshlrev_b32 v44, 1, v14
v_xor_b32 v16, v16, v44
v_lshl_add_u32 v8, v16, 4, v8
s_lshl_b32 s73, s64, 13
s_add_u32 s73, s73, 65536
v_add_u32 v8, s73, v8
v_lshrrev_b32 v12, 5, v0
v_bfe_u32 v44, v0, 3, 2
v_and_b32 v45, 7, v0
v_xor_b32 v16, v44, v45
v_lshlrev_b32 v16, 4, v16
v_lshl_add_u32 v16, v44, 7, v16
v_lshl_add_u32 v16, v12, 11, v16
v_add_u32 v9, s73, v16
v_xor_b32 v10, 64, v9
v_lshlrev_b32 v16, 20, v12
v_lshl_add_u32 v16, v44, 8, v16
v_lshl_add_u32 v16, v45, 4, v16
s_waitcnt vmcnt(24)
v_perm_b32 v46, v46, v46, s7
v_perm_b32 v47, v47, v47, s7
v_perm_b32 v48, v48, v48, s7
v_perm_b32 v49, v49, v49, s7
v_mul_f32 v46, s4, v46
v_mul_f32 v47, s4, v47
v_mul_f32 v48, v48, v46
v_mul_f32 v49, v49, v47
ds_bpermute_b32 v144, v13, v46 offset:0
ds_bpermute_b32 v145, v13, v47 offset:0
ds_bpermute_b32 v146, v13, v48 offset:0
ds_bpermute_b32 v147, v13, v49 offset:0
ds_bpermute_b32 v152, v13, v46 offset:32
ds_bpermute_b32 v153, v13, v47 offset:32
ds_bpermute_b32 v154, v13, v48 offset:32
ds_bpermute_b32 v155, v13, v49 offset:32
ds_bpermute_b32 v160, v13, v46 offset:64
ds_bpermute_b32 v161, v13, v47 offset:64
ds_bpermute_b32 v162, v13, v48 offset:64
ds_bpermute_b32 v163, v13, v49 offset:64
ds_bpermute_b32 v168, v13, v46 offset:96
ds_bpermute_b32 v169, v13, v47 offset:96
ds_bpermute_b32 v170, v13, v48 offset:96
ds_bpermute_b32 v171, v13, v49 offset:96
ds_bpermute_b32 v148, v13, v46 offset:4
ds_bpermute_b32 v149, v13, v47 offset:4
ds_bpermute_b32 v150, v13, v48 offset:4
ds_bpermute_b32 v151, v13, v49 offset:4
ds_bpermute_b32 v156, v13, v46 offset:36
ds_bpermute_b32 v157, v13, v47 offset:36
ds_bpermute_b32 v158, v13, v48 offset:36
ds_bpermute_b32 v159, v13, v49 offset:36
ds_bpermute_b32 v164, v13, v46 offset:68
ds_bpermute_b32 v165, v13, v47 offset:68
ds_bpermute_b32 v166, v13, v48 offset:68
ds_bpermute_b32 v167, v13, v49 offset:68
ds_bpermute_b32 v172, v13, v46 offset:100
ds_bpermute_b32 v173, v13, v47 offset:100
ds_bpermute_b32 v174, v13, v48 offset:100
ds_bpermute_b32 v175, v13, v49 offset:100
s_waitcnt vmcnt(18)
s_waitcnt lgkmcnt(0)
v_perm_b32 v24, v132, v128, s5
v_perm_b32 v28, v130, v134, s5
v_perm_b32 v25, v132, v128, s6
v_perm_b32 v29, v130, v134, s6
v_perm_b32 v26, v133, v129, s5
v_perm_b32 v30, v131, v135, s5
v_perm_b32 v27, v133, v129, s6
v_perm_b32 v31, v131, v135, s6
v_xor_b32 v11, 0, v8
v_cvt_f32_i32 v64, v64
v_cvt_f32_i32 v65, v65
v_cvt_f32_i32 v66, v66
v_cvt_f32_i32 v67, v67
v_cvt_f32_i32 v68, v68
v_cvt_f32_i32 v69, v69
v_cvt_f32_i32 v70, v70
v_cvt_f32_i32 v71, v71
v_pk_fma_f32 v[64:65], v[64:65], v[144:145], v[146:147] op_sel:[0,0,0] op_sel_hi:[1,0,0] neg_lo:[0,0,1] neg_hi:[0,0,1]
v_pk_fma_f32 v[66:67], v[66:67], v[144:145], v[146:147] op_sel:[0,0,0] op_sel_hi:[1,0,0] neg_lo:[0,0,1] neg_hi:[0,0,1]
v_pk_fma_f32 v[68:69], v[68:69], v[144:145], v[146:147] op_sel:[0,1,1] op_sel_hi:[1,1,1] neg_lo:[0,0,1] neg_hi:[0,0,1]
v_pk_fma_f32 v[70:71], v[70:71], v[144:145], v[146:147] op_sel:[0,1,1] op_sel_hi:[1,1,1] neg_lo:[0,0,1] neg_hi:[0,0,1]
v_cvt_pk_bf16_f32 v64, v64, v68
v_cvt_pk_bf16_f32 v65, v65, v69
v_cvt_pk_bf16_f32 v66, v66, v70
v_cvt_pk_bf16_f32 v67, v67, v71
v_dot2_f32_bf16 v32, v64, v24, 0 neg_hi:[0,1,0]
v_dot2_f32_bf16 v33, v65, v25, 0 neg_hi:[0,1,0]
v_dot2_f32_bf16 v34, v66, v26, 0 neg_hi:[0,1,0]
v_dot2_f32_bf16 v35, v67, v27, 0 neg_hi:[0,1,0]
v_dot2_f32_bf16 v36, v64, v28, 0
v_dot2_f32_bf16 v37, v65, v29, 0
v_dot2_f32_bf16 v38, v66, v30, 0
v_dot2_f32_bf16 v39, v67, v31, 0
v_cvt_pk_bf16_f32 v40, v32, v33
s_nop 0
v_cvt_pk_bf16_f32 v41, v34, v35
ds_write_b64 v11, v[40:41] offset:0
v_cvt_pk_bf16_f32 v42, v36, v37
v_cvt_pk_bf16_f32 v43, v38, v39
ds_write_b64 v11, v[42:43] offset:1024
s_waitcnt vmcnt(16)
v_cvt_f32_i32 v72, v72
v_cvt_f32_i32 v73, v73
v_cvt_f32_i32 v74, v74
v_cvt_f32_i32 v75, v75
v_cvt_f32_i32 v76, v76
v_cvt_f32_i32 v77, v77
v_cvt_f32_i32 v78, v78
v_cvt_f32_i32 v79, v79
v_pk_fma_f32 v[72:73], v[72:73], v[152:153], v[154:155] op_sel:[0,0,0] op_sel_hi:[1,0,0] neg_lo:[0,0,1] neg_hi:[0,0,1]
v_pk_fma_f32 v[74:75], v[74:75], v[152:153], v[154:155] op_sel:[0,0,0] op_sel_hi:[1,0,0] neg_lo:[0,0,1] neg_hi:[0,0,1]
v_pk_fma_f32 v[76:77], v[76:77], v[152:153], v[154:155] op_sel:[0,1,1] op_sel_hi:[1,1,1] neg_lo:[0,0,1] neg_hi:[0,0,1]
v_pk_fma_f32 v[78:79], v[78:79], v[152:153], v[154:155] op_sel:[0,1,1] op_sel_hi:[1,1,1] neg_lo:[0,0,1] neg_hi:[0,0,1]
v_cvt_pk_bf16_f32 v72, v72, v76
v_cvt_pk_bf16_f32 v73, v73, v77
v_cvt_pk_bf16_f32 v74, v74, v78
v_cvt_pk_bf16_f32 v75, v75, v79
v_dot2_f32_bf16 v32, v72, v24, 0 neg_hi:[0,1,0]
v_dot2_f32_bf16 v33, v73, v25, 0 neg_hi:[0,1,0]
v_dot2_f32_bf16 v34, v74, v26, 0 neg_hi:[0,1,0]
v_dot2_f32_bf16 v35, v75, v27, 0 neg_hi:[0,1,0]
v_dot2_f32_bf16 v36, v72, v28, 0
v_dot2_f32_bf16 v37, v73, v29, 0
v_dot2_f32_bf16 v38, v74, v30, 0
v_dot2_f32_bf16 v39, v75, v31, 0
v_cvt_pk_bf16_f32 v40, v32, v33
s_nop 0
v_cvt_pk_bf16_f32 v41, v34, v35
ds_write_b64 v11, v[40:41] offset:2048
v_cvt_pk_bf16_f32 v42, v36, v37
v_cvt_pk_bf16_f32 v43, v38, v39
ds_write_b64 v11, v[42:43] offset:3072
s_waitcnt vmcnt(14)
v_cvt_f32_i32 v80, v80
v_cvt_f32_i32 v81, v81
v_cvt_f32_i32 v82, v82
v_cvt_f32_i32 v83, v83
v_cvt_f32_i32 v84, v84
v_cvt_f32_i32 v85, v85
v_cvt_f32_i32 v86, v86
v_cvt_f32_i32 v87, v87
v_pk_fma_f32 v[80:81], v[80:81], v[160:161], v[162:163] op_sel:[0,0,0] op_sel_hi:[1,0,0] neg_lo:[0,0,1] neg_hi:[0,0,1]
v_pk_fma_f32 v[82:83], v[82:83], v[160:161], v[162:163] op_sel:[0,0,0] op_sel_hi:[1,0,0] neg_lo:[0,0,1] neg_hi:[0,0,1]
v_pk_fma_f32 v[84:85], v[84:85], v[160:161], v[162:163] op_sel:[0,1,1] op_sel_hi:[1,1,1] neg_lo:[0,0,1] neg_hi:[0,0,1]
v_pk_fma_f32 v[86:87], v[86:87], v[160:161], v[162:163] op_sel:[0,1,1] op_sel_hi:[1,1,1] neg_lo:[0,0,1] neg_hi:[0,0,1]
v_cvt_pk_bf16_f32 v80, v80, v84
v_cvt_pk_bf16_f32 v81, v81, v85
v_cvt_pk_bf16_f32 v82, v82, v86
v_cvt_pk_bf16_f32 v83, v83, v87
v_dot2_f32_bf16 v32, v80, v24, 0 neg_hi:[0,1,0]
v_dot2_f32_bf16 v33, v81, v25, 0 neg_hi:[0,1,0]
v_dot2_f32_bf16 v34, v82, v26, 0 neg_hi:[0,1,0]
v_dot2_f32_bf16 v35, v83, v27, 0 neg_hi:[0,1,0]
v_dot2_f32_bf16 v36, v80, v28, 0
v_dot2_f32_bf16 v37, v81, v29, 0
v_dot2_f32_bf16 v38, v82, v30, 0
v_dot2_f32_bf16 v39, v83, v31, 0
v_cvt_pk_bf16_f32 v40, v32, v33
s_nop 0
v_cvt_pk_bf16_f32 v41, v34, v35
ds_write_b64 v11, v[40:41] offset:4096
v_cvt_pk_bf16_f32 v42, v36, v37
v_cvt_pk_bf16_f32 v43, v38, v39
ds_write_b64 v11, v[42:43] offset:5120
s_waitcnt vmcnt(12)
v_cvt_f32_i32 v88, v88
v_cvt_f32_i32 v89, v89
v_cvt_f32_i32 v90, v90
v_cvt_f32_i32 v91, v91
v_cvt_f32_i32 v92, v92
v_cvt_f32_i32 v93, v93
v_cvt_f32_i32 v94, v94
v_cvt_f32_i32 v95, v95
v_pk_fma_f32 v[88:89], v[88:89], v[168:169], v[170:171] op_sel:[0,0,0] op_sel_hi:[1,0,0] neg_lo:[0,0,1] neg_hi:[0,0,1]
v_pk_fma_f32 v[90:91], v[90:91], v[168:169], v[170:171] op_sel:[0,0,0] op_sel_hi:[1,0,0] neg_lo:[0,0,1] neg_hi:[0,0,1]
v_pk_fma_f32 v[92:93], v[92:93], v[168:169], v[170:171] op_sel:[0,1,1] op_sel_hi:[1,1,1] neg_lo:[0,0,1] neg_hi:[0,0,1]
v_pk_fma_f32 v[94:95], v[94:95], v[168:169], v[170:171] op_sel:[0,1,1] op_sel_hi:[1,1,1] neg_lo:[0,0,1] neg_hi:[0,0,1]
v_cvt_pk_bf16_f32 v88, v88, v92
v_cvt_pk_bf16_f32 v89, v89, v93
v_cvt_pk_bf16_f32 v90, v90, v94
v_cvt_pk_bf16_f32 v91, v91, v95
v_dot2_f32_bf16 v32, v88, v24, 0 neg_hi:[0,1,0]
v_dot2_f32_bf16 v33, v89, v25, 0 neg_hi:[0,1,0]
v_dot2_f32_bf16 v34, v90, v26, 0 neg_hi:[0,1,0]
v_dot2_f32_bf16 v35, v91, v27, 0 neg_hi:[0,1,0]
v_dot2_f32_bf16 v36, v88, v28, 0
v_dot2_f32_bf16 v37, v89, v29, 0
v_dot2_f32_bf16 v38, v90, v30, 0
v_dot2_f32_bf16 v39, v91, v31, 0
v_cvt_pk_bf16_f32 v40, v32, v33
s_nop 0
v_cvt_pk_bf16_f32 v41, v34, v35
ds_write_b64 v11, v[40:41] offset:6144
v_cvt_pk_bf16_f32 v42, v36, v37
v_cvt_pk_bf16_f32 v43, v38, v39
ds_write_b64 v11, v[42:43] offset:7168
s_waitcnt vmcnt(6)
s_cmp_eq_u32 s74, 0
s_cbranch_scc1 Lp_gk
s_barrier
s_mov_b32 s74, 0
Lp_gk:
v_perm_b32 v24, v140, v136, s5
v_perm_b32 v28, v138, v142, s5
v_perm_b32 v25, v140, v136, s6
v_perm_b32 v29, v138, v142, s6
v_perm_b32 v26, v141, v137, s5
v_perm_b32 v30, v139, v143, s5
v_perm_b32 v27, v141, v137, s6
v_perm_b32 v31, v139, v143, s6
v_xor_b32 v11, 16, v8
v_cvt_f32_i32 v96, v96
v_cvt_f32_i32 v97, v97
v_cvt_f32_i32 v98, v98
v_cvt_f32_i32 v99, v99
v_cvt_f32_i32 v100, v100
v_cvt_f32_i32 v101, v101
v_cvt_f32_i32 v102, v102
v_cvt_f32_i32 v103, v103
v_pk_fma_f32 v[96:97], v[96:97], v[148:149], v[150:151] op_sel:[0,0,0] op_sel_hi:[1,0,0] neg_lo:[0,0,1] neg_hi:[0,0,1]
v_pk_fma_f32 v[98:99], v[98:99], v[148:149], v[150:151] op_sel:[0,0,0] op_sel_hi:[1,0,0] neg_lo:[0,0,1] neg_hi:[0,0,1]
v_pk_fma_f32 v[100:101], v[100:101], v[148:149], v[150:151] op_sel:[0,1,1] op_sel_hi:[1,1,1] neg_lo:[0,0,1] neg_hi:[0,0,1]
v_pk_fma_f32 v[102:103], v[102:103], v[148:149], v[150:151] op_sel:[0,1,1] op_sel_hi:[1,1,1] neg_lo:[0,0,1] neg_hi:[0,0,1]
v_cvt_pk_bf16_f32 v96, v96, v100
v_cvt_pk_bf16_f32 v97, v97, v101
v_cvt_pk_bf16_f32 v98, v98, v102
v_cvt_pk_bf16_f32 v99, v99, v103
v_dot2_f32_bf16 v32, v96, v24, 0 neg_hi:[0,1,0]
v_dot2_f32_bf16 v33, v97, v25, 0 neg_hi:[0,1,0]
v_dot2_f32_bf16 v34, v98, v26, 0 neg_hi:[0,1,0]
v_dot2_f32_bf16 v35, v99, v27, 0 neg_hi:[0,1,0]
v_dot2_f32_bf16 v36, v96, v28, 0
v_dot2_f32_bf16 v37, v97, v29, 0
v_dot2_f32_bf16 v38, v98, v30, 0
v_dot2_f32_bf16 v39, v99, v31, 0
v_cvt_pk_bf16_f32 v40, v32, v33
s_nop 0
v_cvt_pk_bf16_f32 v41, v34, v35
ds_write_b64 v11, v[40:41] offset:0
v_cvt_pk_bf16_f32 v42, v36, v37
v_cvt_pk_bf16_f32 v43, v38, v39
ds_write_b64 v11, v[42:43] offset:1024
s_waitcnt vmcnt(4)
v_cvt_f32_i32 v104, v104
v_cvt_f32_i32 v105, v105
v_cvt_f32_i32 v106, v106
v_cvt_f32_i32 v107, v107
v_cvt_f32_i32 v108, v108
v_cvt_f32_i32 v109, v109
v_cvt_f32_i32 v110, v110
v_cvt_f32_i32 v111, v111
v_pk_fma_f32 v[104:105], v[104:105], v[156:157], v[158:159] op_sel:[0,0,0] op_sel_hi:[1,0,0] neg_lo:[0,0,1] neg_hi:[0,0,1]
v_pk_fma_f32 v[106:107], v[106:107], v[156:157], v[158:159] op_sel:[0,0,0] op_sel_hi:[1,0,0] neg_lo:[0,0,1] neg_hi:[0,0,1]
v_pk_fma_f32 v[108:109], v[108:109], v[156:157], v[158:159] op_sel:[0,1,1] op_sel_hi:[1,1,1] neg_lo:[0,0,1] neg_hi:[0,0,1]
v_pk_fma_f32 v[110:111], v[110:111], v[156:157], v[158:159] op_sel:[0,1,1] op_sel_hi:[1,1,1] neg_lo:[0,0,1] neg_hi:[0,0,1]
v_cvt_pk_bf16_f32 v104, v104, v108
v_cvt_pk_bf16_f32 v105, v105, v109
v_cvt_pk_bf16_f32 v106, v106, v110
v_cvt_pk_bf16_f32 v107, v107, v111
v_dot2_f32_bf16 v32, v104, v24, 0 neg_hi:[0,1,0]
v_dot2_f32_bf16 v33, v105, v25, 0 neg_hi:[0,1,0]
v_dot2_f32_bf16 v34, v106, v26, 0 neg_hi:[0,1,0]
v_dot2_f32_bf16 v35, v107, v27, 0 neg_hi:[0,1,0]
v_dot2_f32_bf16 v36, v104, v28, 0
v_dot2_f32_bf16 v37, v105, v29, 0
v_dot2_f32_bf16 v38, v106, v30, 0
v_dot2_f32_bf16 v39, v107, v31, 0
v_cvt_pk_bf16_f32 v40, v32, v33
s_nop 0
v_cvt_pk_bf16_f32 v41, v34, v35
ds_write_b64 v11, v[40:41] offset:2048
v_cvt_pk_bf16_f32 v42, v36, v37
v_cvt_pk_bf16_f32 v43, v38, v39
ds_write_b64 v11, v[42:43] offset:3072
s_waitcnt vmcnt(2)
v_cvt_f32_i32 v112, v112
v_cvt_f32_i32 v113, v113
v_cvt_f32_i32 v114, v114
v_cvt_f32_i32 v115, v115
v_cvt_f32_i32 v116, v116
v_cvt_f32_i32 v117, v117
v_cvt_f32_i32 v118, v118
v_cvt_f32_i32 v119, v119
v_pk_fma_f32 v[112:113], v[112:113], v[164:165], v[166:167] op_sel:[0,0,0] op_sel_hi:[1,0,0] neg_lo:[0,0,1] neg_hi:[0,0,1]
v_pk_fma_f32 v[114:115], v[114:115], v[164:165], v[166:167] op_sel:[0,0,0] op_sel_hi:[1,0,0] neg_lo:[0,0,1] neg_hi:[0,0,1]
v_pk_fma_f32 v[116:117], v[116:117], v[164:165], v[166:167] op_sel:[0,1,1] op_sel_hi:[1,1,1] neg_lo:[0,0,1] neg_hi:[0,0,1]
v_pk_fma_f32 v[118:119], v[118:119], v[164:165], v[166:167] op_sel:[0,1,1] op_sel_hi:[1,1,1] neg_lo:[0,0,1] neg_hi:[0,0,1]
v_cvt_pk_bf16_f32 v112, v112, v116
v_cvt_pk_bf16_f32 v113, v113, v117
v_cvt_pk_bf16_f32 v114, v114, v118
v_cvt_pk_bf16_f32 v115, v115, v119
v_dot2_f32_bf16 v32, v112, v24, 0 neg_hi:[0,1,0]
v_dot2_f32_bf16 v33, v113, v25, 0 neg_hi:[0,1,0]
v_dot2_f32_bf16 v34, v114, v26, 0 neg_hi:[0,1,0]
v_dot2_f32_bf16 v35, v115, v27, 0 neg_hi:[0,1,0]
v_dot2_f32_bf16 v36, v112, v28, 0
v_dot2_f32_bf16 v37, v113, v29, 0
v_dot2_f32_bf16 v38, v114, v30, 0
v_dot2_f32_bf16 v39, v115, v31, 0
v_cvt_pk_bf16_f32 v40, v32, v33
s_nop 0
v_cvt_pk_bf16_f32 v41, v34, v35
ds_write_b64 v11, v[40:41] offset:4096
v_cvt_pk_bf16_f32 v42, v36, v37
v_cvt_pk_bf16_f32 v43, v38, v39
ds_write_b64 v11, v[42:43] offset:5120
s_waitcnt vmcnt(0)
v_cvt_f32_i32 v120, v120
v_cvt_f32_i32 v121, v121
v_cvt_f32_i32 v122, v122
v_cvt_f32_i32 v123, v123
v_cvt_f32_i32 v124, v124
v_cvt_f32_i32 v125, v125
v_cvt_f32_i32 v126, v126
v_cvt_f32_i32 v127, v127
v_pk_fma_f32 v[120:121], v[120:121], v[172:173], v[174:175] op_sel:[0,0,0] op_sel_hi:[1,0,0] neg_lo:[0,0,1] neg_hi:[0,0,1]
v_pk_fma_f32 v[122:123], v[122:123], v[172:173], v[174:175] op_sel:[0,0,0] op_sel_hi:[1,0,0] neg_lo:[0,0,1] neg_hi:[0,0,1]
v_pk_fma_f32 v[124:125], v[124:125], v[172:173], v[174:175] op_sel:[0,1,1] op_sel_hi:[1,1,1] neg_lo:[0,0,1] neg_hi:[0,0,1]
v_pk_fma_f32 v[126:127], v[126:127], v[172:173], v[174:175] op_sel:[0,1,1] op_sel_hi:[1,1,1] neg_lo:[0,0,1] neg_hi:[0,0,1]
v_cvt_pk_bf16_f32 v120, v120, v124
v_cvt_pk_bf16_f32 v121, v121, v125
v_cvt_pk_bf16_f32 v122, v122, v126
v_cvt_pk_bf16_f32 v123, v123, v127
v_dot2_f32_bf16 v32, v120, v24, 0 neg_hi:[0,1,0]
v_dot2_f32_bf16 v33, v121, v25, 0 neg_hi:[0,1,0]
v_dot2_f32_bf16 v34, v122, v26, 0 neg_hi:[0,1,0]
v_dot2_f32_bf16 v35, v123, v27, 0 neg_hi:[0,1,0]
v_dot2_f32_bf16 v36, v120, v28, 0
v_dot2_f32_bf16 v37, v121, v29, 0
v_dot2_f32_bf16 v38, v122, v30, 0
v_dot2_f32_bf16 v39, v123, v31, 0
v_cvt_pk_bf16_f32 v40, v32, v33
s_nop 0
v_cvt_pk_bf16_f32 v41, v34, v35
ds_write_b64 v11, v[40:41] offset:6144
v_cvt_pk_bf16_f32 v42, v36, v37
v_cvt_pk_bf16_f32 v43, v38, v39
ds_write_b64 v11, v[42:43] offset:7168
s_waitcnt lgkmcnt(0)
ds_read_b128 v[192:195], v9 offset:0
ds_read_b128 v[196:199], v10 offset:512
ds_read_b128 v[200:203], v9 offset:1024
ds_read_b128 v[204:207], v10 offset:1536
ds_read_b128 v[208:211], v9 offset:4096
ds_read_b128 v[212:215], v10 offset:4608
ds_read_b128 v[216:219], v9 offset:5120
ds_read_b128 v[220:223], v10 offset:5632
s_waitcnt lgkmcnt(7)
buffer_store_dwordx4 v[192:195], v16, s[8:11], s69 offen offset:0 sc1
s_waitcnt lgkmcnt(6)
buffer_store_dwordx4 v[196:199], v16, s[8:11], s69 offen offset:1024 sc1
s_waitcnt lgkmcnt(5)
buffer_store_dwordx4 v[200:203], v16, s[8:11], s70 offen offset:0 sc1
s_waitcnt lgkmcnt(4)
buffer_store_dwordx4 v[204:207], v16, s[8:11], s70 offen offset:1024 sc1
s_waitcnt lgkmcnt(3)
buffer_store_dwordx4 v[208:211], v16, s[8:11], s71 offen offset:0 sc1
s_waitcnt lgkmcnt(2)
buffer_store_dwordx4 v[212:215], v16, s[8:11], s71 offen offset:1024 sc1
s_waitcnt lgkmcnt(1)
buffer_store_dwordx4 v[216:219], v16, s[8:11], s72 offen offset:0 sc1
s_waitcnt lgkmcnt(0)
buffer_store_dwordx4 v[220:223], v16, s[8:11], s72 offen offset:1024 sc1
s_branch Lp_next
Lp_v:
s_lshr_b32 s49, s45, 3
s_bfe_u32 s50, s45, 0x20001
s_and_b32 s51, s45, 1
s_lshl_b32 s52, s49, 11
s_lshl_b32 s53, s48, 7
s_add_u32 s52, s52, s53
s_lshl_b32 s53, s50, 5
s_add_u32 s52, s52, s53
s_lshl_b32 s53, s52, 10
s_lshl_b32 s54, s51, 9
s_add_u32 s53, s53, s54
s_add_u32 s54, s53, 16384
s_lshl_b32 s55, s52, 3
s_lshl_b32 s56, s51, 2
s_add_u32 s55, s55, s56
buffer_load_dword v46, v5, s[28:31], s55 offen
buffer_load_dword v47, v5, s[32:35], s55 offen
buffer_load_dwordx4 v[64:67], v4, s[24:27], s53 offen offset:0
buffer_load_dwordx4 v[68:71], v4, s[24:27], s53 offen offset:1024
buffer_load_dwordx4 v[72:75], v4, s[24:27], s53 offen offset:2048
buffer_load_dwordx4 v[76:79], v4, s[24:27], s53 offen offset:3072
buffer_load_dwordx4 v[80:83], v4, s[24:27], s54 offen offset:0
buffer_load_dwordx4 v[84:87], v4, s[24:27], s54 offen offset:1024
buffer_load_dwordx4 v[88:91], v4, s[24:27], s54 offen offset:2048
buffer_load_dwordx4 v[92:95], v4, s[24:27], s54 offen offset:3072
s_cmp_eq_u32 s47, 17072128
s_cbranch_scc1 Lp_nf2994
s_waitcnt vmcnt(10) lgkmcnt(0)
s_mul_i32 s66, s65, 0x9E3779B1
s_add_u32 s66, s66, 0x7F4A7C15
v_mov_b32 v17, s66
s_mov_b64 exec, 1
buffer_store_dword v17, v18, s[8:11], s47 offen sc1
s_mov_b64 exec, -1
Lp_nf2994:
buffer_load_dwordx4 v[96:99], v4, s[24:27], s53 offen offset:256
buffer_load_dwordx4 v[100:103], v4, s[24:27], s53 offen offset:1280
buffer_load_dwordx4 v[104:107], v4, s[24:27], s53 offen offset:2304
buffer_load_dwordx4 v[108:111], v4, s[24:27], s53 offen offset:3328
buffer_load_dwordx4 v[112:115], v4, s[24:27], s54 offen offset:256
buffer_load_dwordx4 v[116:119], v4, s[24:27], s54 offen offset:1280
buffer_load_dwordx4 v[120:123], v4, s[24:27], s54 offen offset:2304
buffer_load_dwordx4 v[124:127], v4, s[24:27], s54 offen offset:3328
s_lshl_b32 s56, s49, 20
s_lshl_b32 s57, s51, 19
s_add_u32 s56, s56, s57
s_lshl_b32 s57, s48, 14
s_add_u32 s56, s56, s57
s_add_u32 s56, s56, 8388608
s_lshr_b32 s57, s50, 1
s_lshl_b32 s57, s57, 13
s_add_u32 s56, s56, s57
s_and_b32 s57, s50, 1
s_lshl_b32 s57, s57, 10
s_add_u32 s56, s56, s57
s_add_u32 s57, s56, 4096
s_add_u32 s58, s56, 0x40000
s_add_u32 s59, s58, 4096
s_lshl_b32 s46, s49, 12
s_lshl_b32 s60, s48, 8
s_add_u32 s46, s46, s60
s_and_b32 s60, s45, 7
s_lshl_b32 s60, s60, 5
s_add_u32 s46, s46, s60
s_add_u32 s46, s46, 16908288
s_cmp_lg_u32 s3, 1
s_cbranch_scc1 Lp_nbv
s_barrier
s_mov_b32 s3, 2
Lp_nbv:
s_waitcnt vmcnt(16)
v_lshlrev_b32 v48, 16, v46
v_and_b32 v49, 0xffff0000, v46
v_lshlrev_b32 v50, 16, v47
v_and_b32 v51, 0xffff0000, v47
v_mul_f32 v50, v50, v48
v_mul_f32 v51, v51, v49
ds_bpermute_b32 v128, v19, v48 offset:0
ds_bpermute_b32 v129, v19, v48 offset:4
ds_bpermute_b32 v130, v19, v48 offset:8
ds_bpermute_b32 v131, v19, v48 offset:12
ds_bpermute_b32 v132, v19, v48 offset:64
ds_bpermute_b32 v133, v19, v48 offset:68
ds_bpermute_b32 v134, v19, v48 offset:72
ds_bpermute_b32 v135, v19, v48 offset:76
ds_bpermute_b32 v136, v19, v50 offset:0
ds_bpermute_b32 v137, v19, v50 offset:4
ds_bpermute_b32 v138, v19, v50 offset:8
ds_bpermute_b32 v139, v19, v50 offset:12
ds_bpermute_b32 v140, v19, v50 offset:64
ds_bpermute_b32 v141, v19, v50 offset:68
ds_bpermute_b32 v142, v19, v50 offset:72
ds_bpermute_b32 v143, v19, v50 offset:76
ds_bpermute_b32 v144, v19, v49 offset:0
ds_bpermute_b32 v145, v19, v49 offset:4
ds_bpermute_b32 v146, v19, v49 offset:8
ds_bpermute_b32 v147, v19, v49 offset:12
ds_bpermute_b32 v148, v19, v49 offset:64
ds_bpermute_b32 v149, v19, v49 offset:68
ds_bpermute_b32 v150, v19, v49 offset:72
ds_bpermute_b32 v151, v19, v49 offset:76
ds_bpermute_b32 v152, v19, v51 offset:0
ds_bpermute_b32 v153, v19, v51 offset:4
ds_bpermute_b32 v154, v19, v51 offset:8
ds_bpermute_b32 v155, v19, v51 offset:12
ds_bpermute_b32 v156, v19, v51 offset:64
ds_bpermute_b32 v157, v19, v51 offset:68
ds_bpermute_b32 v158, v19, v51 offset:72
ds_bpermute_b32 v159, v19, v51 offset:76
s_waitcnt vmcnt(8)
s_waitcnt lgkmcnt(0)
s_cmp_eq_u32 s74, 0
s_cbranch_scc1 Lp_gv
s_barrier
s_mov_b32 s74, 0
Lp_gv:
v_cvt_f32_i32 v64, v64
v_cvt_f32_i32 v65, v65
v_cvt_f32_i32 v66, v66
v_cvt_f32_i32 v67, v67
v_pk_fma_f32 v[64:65], v[64:65], v[128:129], v[136:137] op_sel:[0,0,0] op_sel_hi:[1,0,0] neg_lo:[0,0,1] neg_hi:[0,0,1]
v_pk_fma_f32 v[66:67], v[66:67], v[128:129], v[136:137] op_sel:[0,0,0] op_sel_hi:[1,0,0] neg_lo:[0,0,1] neg_hi:[0,0,1]
v_cvt_f32_i32 v68, v68
v_cvt_f32_i32 v69, v69
v_cvt_f32_i32 v70, v70
v_cvt_f32_i32 v71, v71
v_pk_fma_f32 v[68:69], v[68:69], v[128:129], v[136:137] op_sel:[0,1,1] op_sel_hi:[1,1,1] neg_lo:[0,0,1] neg_hi:[0,0,1]
v_pk_fma_f32 v[70:71], v[70:71], v[128:129], v[136:137] op_sel:[0,1,1] op_sel_hi:[1,1,1] neg_lo:[0,0,1] neg_hi:[0,0,1]
v_cvt_f32_i32 v72, v72
v_cvt_f32_i32 v73, v73
v_cvt_f32_i32 v74, v74
v_cvt_f32_i32 v75, v75
v_pk_fma_f32 v[72:73], v[72:73], v[130:131], v[138:139] op_sel:[0,0,0] op_sel_hi:[1,0,0] neg_lo:[0,0,1] neg_hi:[0,0,1]
v_pk_fma_f32 v[74:75], v[74:75], v[130:131], v[138:139] op_sel:[0,0,0] op_sel_hi:[1,0,0] neg_lo:[0,0,1] neg_hi:[0,0,1]
v_cvt_f32_i32 v76, v76
v_cvt_f32_i32 v77, v77
v_cvt_f32_i32 v78, v78
v_cvt_f32_i32 v79, v79
v_pk_fma_f32 v[76:77], v[76:77], v[130:131], v[138:139] op_sel:[0,1,1] op_sel_hi:[1,1,1] neg_lo:[0,0,1] neg_hi:[0,0,1]
v_pk_fma_f32 v[78:79], v[78:79], v[130:131], v[138:139] op_sel:[0,1,1] op_sel_hi:[1,1,1] neg_lo:[0,0,1] neg_hi:[0,0,1]
v_cvt_f32_i32 v80, v80
v_cvt_f32_i32 v81, v81
v_cvt_f32_i32 v82, v82
v_cvt_f32_i32 v83, v83
v_pk_fma_f32 v[80:81], v[80:81], v[132:133], v[140:141] op_sel:[0,0,0] op_sel_hi:[1,0,0] neg_lo:[0,0,1] neg_hi:[0,0,1]
v_pk_fma_f32 v[82:83], v[82:83], v[132:133], v[140:141] op_sel:[0,0,0] op_sel_hi:[1,0,0] neg_lo:[0,0,1] neg_hi:[0,0,1]
v_cvt_f32_i32 v84, v84
v_cvt_f32_i32 v85, v85
v_cvt_f32_i32 v86, v86
v_cvt_f32_i32 v87, v87
v_pk_fma_f32 v[84:85], v[84:85], v[132:133], v[140:141] op_sel:[0,1,1] op_sel_hi:[1,1,1] neg_lo:[0,0,1] neg_hi:[0,0,1]
v_pk_fma_f32 v[86:87], v[86:87], v[132:133], v[140:141] op_sel:[0,1,1] op_sel_hi:[1,1,1] neg_lo:[0,0,1] neg_hi:[0,0,1]
v_cvt_f32_i32 v88, v88
v_cvt_f32_i32 v89, v89
v_cvt_f32_i32 v90, v90
v_cvt_f32_i32 v91, v91
v_pk_fma_f32 v[88:89], v[88:89], v[134:135], v[142:143] op_sel:[0,0,0] op_sel_hi:[1,0,0] neg_lo:[0,0,1] neg_hi:[0,0,1]
v_pk_fma_f32 v[90:91], v[90:91], v[134:135], v[142:143] op_sel:[0,0,0] op_sel_hi:[1,0,0] neg_lo:[0,0,1] neg_hi:[0,0,1]
v_cvt_f32_i32 v92, v92
v_cvt_f32_i32 v93, v93
v_cvt_f32_i32 v94, v94
v_cvt_f32_i32 v95, v95
v_pk_fma_f32 v[92:93], v[92:93], v[134:135], v[142:143] op_sel:[0,1,1] op_sel_hi:[1,1,1] neg_lo:[0,0,1] neg_hi:[0,0,1]
v_pk_fma_f32 v[94:95], v[94:95], v[134:135], v[142:143] op_sel:[0,1,1] op_sel_hi:[1,1,1] neg_lo:[0,0,1] neg_hi:[0,0,1]
v_cvt_pk_bf16_f32 v192, v64, v68
v_cvt_pk_bf16_f32 v193, v72, v76
v_cvt_pk_bf16_f32 v194, v80, v84
v_cvt_pk_bf16_f32 v195, v88, v92
buffer_store_dwordx4 v[192:195], v6, s[8:11], s56 offen offset:0 sc1
v_cvt_pk_bf16_f32 v196, v65, v69
v_cvt_pk_bf16_f32 v197, v73, v77
v_cvt_pk_bf16_f32 v198, v81, v85
v_cvt_pk_bf16_f32 v199, v89, v93
buffer_store_dwordx4 v[196:199], v6, s[8:11], s56 offen offset:2048 sc1
v_cvt_pk_bf16_f32 v200, v66, v70
v_cvt_pk_bf16_f32 v201, v74, v78
v_cvt_pk_bf16_f32 v202, v82, v86
v_cvt_pk_bf16_f32 v203, v90, v94
buffer_store_dwordx4 v[200:203], v6, s[8:11], s57 offen offset:0 sc1
v_cvt_pk_bf16_f32 v204, v67, v71
v_cvt_pk_bf16_f32 v205, v75, v79
v_cvt_pk_bf16_f32 v206, v83, v87
v_cvt_pk_bf16_f32 v207, v91, v95
buffer_store_dwordx4 v[204:207], v6, s[8:11], s57 offen offset:2048 sc1
s_waitcnt vmcnt(4)
v_cvt_f32_i32 v96, v96
v_cvt_f32_i32 v97, v97
v_cvt_f32_i32 v98, v98
v_cvt_f32_i32 v99, v99
v_pk_fma_f32 v[96:97], v[96:97], v[144:145], v[152:153] op_sel:[0,0,0] op_sel_hi:[1,0,0] neg_lo:[0,0,1] neg_hi:[0,0,1]
v_pk_fma_f32 v[98:99], v[98:99], v[144:145], v[152:153] op_sel:[0,0,0] op_sel_hi:[1,0,0] neg_lo:[0,0,1] neg_hi:[0,0,1]
v_cvt_f32_i32 v100, v100
v_cvt_f32_i32 v101, v101
v_cvt_f32_i32 v102, v102
v_cvt_f32_i32 v103, v103
v_pk_fma_f32 v[100:101], v[100:101], v[144:145], v[152:153] op_sel:[0,1,1] op_sel_hi:[1,1,1] neg_lo:[0,0,1] neg_hi:[0,0,1]
v_pk_fma_f32 v[102:103], v[102:103], v[144:145], v[152:153] op_sel:[0,1,1] op_sel_hi:[1,1,1] neg_lo:[0,0,1] neg_hi:[0,0,1]
v_cvt_f32_i32 v104, v104
v_cvt_f32_i32 v105, v105
v_cvt_f32_i32 v106, v106
v_cvt_f32_i32 v107, v107
v_pk_fma_f32 v[104:105], v[104:105], v[146:147], v[154:155] op_sel:[0,0,0] op_sel_hi:[1,0,0] neg_lo:[0,0,1] neg_hi:[0,0,1]
v_pk_fma_f32 v[106:107], v[106:107], v[146:147], v[154:155] op_sel:[0,0,0] op_sel_hi:[1,0,0] neg_lo:[0,0,1] neg_hi:[0,0,1]
v_cvt_f32_i32 v108, v108
v_cvt_f32_i32 v109, v109
v_cvt_f32_i32 v110, v110
v_cvt_f32_i32 v111, v111
v_pk_fma_f32 v[108:109], v[108:109], v[146:147], v[154:155] op_sel:[0,1,1] op_sel_hi:[1,1,1] neg_lo:[0,0,1] neg_hi:[0,0,1]
v_pk_fma_f32 v[110:111], v[110:111], v[146:147], v[154:155] op_sel:[0,1,1] op_sel_hi:[1,1,1] neg_lo:[0,0,1] neg_hi:[0,0,1]
v_cvt_f32_i32 v112, v112
v_cvt_f32_i32 v113, v113
v_cvt_f32_i32 v114, v114
v_cvt_f32_i32 v115, v115
v_pk_fma_f32 v[112:113], v[112:113], v[148:149], v[156:157] op_sel:[0,0,0] op_sel_hi:[1,0,0] neg_lo:[0,0,1] neg_hi:[0,0,1]
v_pk_fma_f32 v[114:115], v[114:115], v[148:149], v[156:157] op_sel:[0,0,0] op_sel_hi:[1,0,0] neg_lo:[0,0,1] neg_hi:[0,0,1]
v_cvt_f32_i32 v116, v116
v_cvt_f32_i32 v117, v117
v_cvt_f32_i32 v118, v118
v_cvt_f32_i32 v119, v119
v_pk_fma_f32 v[116:117], v[116:117], v[148:149], v[156:157] op_sel:[0,1,1] op_sel_hi:[1,1,1] neg_lo:[0,0,1] neg_hi:[0,0,1]
v_pk_fma_f32 v[118:119], v[118:119], v[148:149], v[156:157] op_sel:[0,1,1] op_sel_hi:[1,1,1] neg_lo:[0,0,1] neg_hi:[0,0,1]
v_cvt_f32_i32 v120, v120
v_cvt_f32_i32 v121, v121
v_cvt_f32_i32 v122, v122
v_cvt_f32_i32 v123, v123
v_pk_fma_f32 v[120:121], v[120:121], v[150:151], v[158:159] op_sel:[0,0,0] op_sel_hi:[1,0,0] neg_lo:[0,0,1] neg_hi:[0,0,1]
v_pk_fma_f32 v[122:123], v[122:123], v[150:151], v[158:159] op_sel:[0,0,0] op_sel_hi:[1,0,0] neg_lo:[0,0,1] neg_hi:[0,0,1]
v_cvt_f32_i32 v124, v124
v_cvt_f32_i32 v125, v125
v_cvt_f32_i32 v126, v126
v_cvt_f32_i32 v127, v127
v_pk_fma_f32 v[124:125], v[124:125], v[150:151], v[158:159] op_sel:[0,1,1] op_sel_hi:[1,1,1] neg_lo:[0,0,1] neg_hi:[0,0,1]
v_pk_fma_f32 v[126:127], v[126:127], v[150:151], v[158:159] op_sel:[0,1,1] op_sel_hi:[1,1,1] neg_lo:[0,0,1] neg_hi:[0,0,1]
v_cvt_pk_bf16_f32 v208, v96, v100
v_cvt_pk_bf16_f32 v209, v104, v108
v_cvt_pk_bf16_f32 v210, v112, v116
v_cvt_pk_bf16_f32 v211, v120, v124
buffer_store_dwordx4 v[208:211], v6, s[8:11], s58 offen offset:0 sc1
v_cvt_pk_bf16_f32 v212, v97, v101
v_cvt_pk_bf16_f32 v213, v105, v109
v_cvt_pk_bf16_f32 v214, v113, v117
v_cvt_pk_bf16_f32 v215, v121, v125
buffer_store_dwordx4 v[212:215], v6, s[8:11], s58 offen offset:2048 sc1
v_cvt_pk_bf16_f32 v216, v98, v102
v_cvt_pk_bf16_f32 v217, v106, v110
v_cvt_pk_bf16_f32 v218, v114, v118
v_cvt_pk_bf16_f32 v219, v122, v126
buffer_store_dwordx4 v[216:219], v6, s[8:11], s59 offen offset:0 sc1
v_cvt_pk_bf16_f32 v220, v99, v103
v_cvt_pk_bf16_f32 v221, v107, v111
v_cvt_pk_bf16_f32 v222, v115, v119
v_cvt_pk_bf16_f32 v223, v123, v127
buffer_store_dwordx4 v[220:223], v6, s[8:11], s59 offen offset:2048 sc1
s_branch Lp_next
Lp_end:
s_waitcnt vmcnt(0) lgkmcnt(0)
s_mul_i32 s66, s65, 0x9E3779B1
s_add_u32 s66, s66, 0x7F4A7C15
v_mov_b32 v17, s66
s_mov_b64 exec, 1
buffer_store_dword v17, v18, s[8:11], s47 offen sc1
s_mov_b64 exec, -1
s_lshl_b32 s47, s68, 5
s_add_u32 s47, s47, 17039360
s_waitcnt vmcnt(63) lgkmcnt(0)
s_mul_i32 s66, s65, 0x9E3779B1
s_add_u32 s66, s66, 0x7F4A7C15
v_mov_b32 v17, s66
s_mov_b64 exec, 1
buffer_store_dword v17, v18, s[8:11], s47 offen sc1
s_mov_b64 exec, -1
s_add_u32 s49, s2, s64
s_cmp_lg_u32 s49, 0
s_cbranch_scc1 Lp_done
v_lshlrev_b32 v1, 5, v0
v_min_u32 v3, 15, v0
v_lshlrev_b32 v3, 5, v3
s_mov_b32 s49, 0x20000
s_mov_b32 s50, 17040896
s_mov_b32 s51, 17042944
s_mov_b32 s52, 17044992
s_mov_b32 s53, 17047040
s_mov_b32 s54, 17049088
s_mov_b32 s55, 17051136
s_mov_b32 s56, 17053184
Lp_ep:
buffer_load_dword v20, v1, s[8:11], s50 offen sc1
buffer_load_dword v21, v1, s[8:11], s51 offen sc1
buffer_load_dword v22, v1, s[8:11], s52 offen sc1
buffer_load_dword v23, v1, s[8:11], s53 offen sc1
buffer_load_dword v24, v1, s[8:11], s54 offen sc1
buffer_load_dword v25, v1, s[8:11], s55 offen sc1
buffer_load_dword v26, v3, s[8:11], s56 offen sc1
buffer_load_dword v27, v3, s[8:11], s56 offen sc1
s_waitcnt vmcnt(0)
v_xor_b32 v20, s66, v20
v_xor_b32 v21, s66, v21
v_xor_b32 v22, s66, v22
v_xor_b32 v23, s66, v23
v_xor_b32 v24, s66, v24
v_xor_b32 v25, s66, v25
v_xor_b32 v26, s66, v26
v_xor_b32 v27, s66, v27
v_or3_b32 v20, v20, v21, v22
v_or3_b32 v20, v20, v23, v24
v_or3_b32 v20, v20, v25, v26
v_or_b32 v20, v20, v27
v_cmp_ne_u32 vcc, 0, v20
s_sub_u32 s49, s49, 1
s_cbranch_scc1 Lp_done
s_cbranch_vccz Lp_bump
s_sleep 8
s_branch Lp_ep
Lp_bump:
s_mov_b32 s50, 17076224
s_mov_b64 exec, 1
buffer_store_dword v17, v18, s[8:11], s50 offen sc1
s_mov_b64 exec, -1
Lp_done:
s_endpgm
La_att:
s_load_dwordx2 s[12:13], s[0:1], 0
s_load_dwordx2 s[16:17], s[0:1], 56
s_load_dwordx2 s[20:21], s[0:1], 64
s_load_dwordx2 s[24:25], s[0:1], 88
s_load_dwordx2 s[48:49], s[0:1], 8
s_load_dwordx2 s[52:53], s[0:1], 32
s_lshr_b32 s37, s2, 3
s_sub_u32 s37, s37, 6
s_and_b32 s38, s2, 1
s_mul_i32 s38, s38, 26
s_add_u32 s37, s37, s38
s_and_b32 s38, s37, 1
s_and_b32 s28, s2, 6
s_add_u32 s28, s28, s38
s_lshr_b32 s37, s37, 1
s_mul_i32 s29, s37, 80
s_cmp_eq_u32 s37, 25
s_cselect_b32 s30, 2, 0
s_min_u32 s29, s29, 1968
s_sub_u32 s47, s64, 1
s_mul_i32 s47, s47, 28
s_min_u32 s47, s47, 55
s_cmp_eq_u32 s64, 3
s_cselect_b32 s46, 6, 7
s_add_u32 s37, s47, s29
s_lshl_b32 s37, s37, 9
s_lshl_b32 s39, s28, 20
s_add_u32 s38, s37, s39
v_mul_u32_u24 v2, s46, v14
v_lshlrev_b32 v3, 9, v2
v_lshl_add_u32 v3, v15, 4, v3
s_mov_b32 s14, 8388608
s_mov_b32 s15, 0x00020000
s_mov_b32 s18, 1048576
s_mov_b32 s19, 0x00020000
s_mov_b32 s22, 1048576
s_mov_b32 s23, 0x00020000
s_mov_b32 s26, 8388608
s_mov_b32 s27, 0x00020000
s_mov_b32 s50, 16777216
s_mov_b32 s51, 0x00020000
s_mov_b32 s54, 16777216
s_mov_b32 s55, 0x00020000
s_waitcnt lgkmcnt(0)
s_cmp_lg_u32 s3, 0
s_cbranch_scc1 La_nb
s_barrier
La_nb:
s_cmp_eq_u32 s64, 0
s_cbranch_scc1 La_noq
s_cmp_eq_u32 s64, 3
s_cbranch_scc1 La_q0a
buffer_load_dwordx4 v[188:191], v3, s[12:15], s38 offen offset:0
buffer_load_dwordx4 v[192:195], v3, s[12:15], s38 offen offset:256
buffer_load_dwordx4 v[196:199], v3, s[16:19], s37 offen offset:0
buffer_load_dwordx4 v[200:203], v3, s[16:19], s37 offen offset:256
buffer_load_dwordx4 v[204:207], v3, s[20:23], s37 offen offset:0
buffer_load_dwordx4 v[208:211], v3, s[20:23], s37 offen offset:256
La_q0a:
buffer_load_dwordx4 v[212:215], v3, s[12:15], s38 offen offset:512
buffer_load_dwordx4 v[216:219], v3, s[12:15], s38 offen offset:768
buffer_load_dwordx4 v[220:223], v3, s[16:19], s37 offen offset:512
buffer_load_dwordx4 v[224:227], v3, s[16:19], s37 offen offset:768
buffer_load_dwordx4 v[228:231], v3, s[20:23], s37 offen offset:512
buffer_load_dwordx4 v[232:235], v3, s[20:23], s37 offen offset:768
La_noq:
s_add_u32 s62, s8, 16777216
s_addc_u32 s63, s9, 0
s_load_dword s65, s[62:63], 299008
v_add_u32 v16, s47, v2
v_lshrrev_b32 v17, 2, v15
v_and_b32 v18, 3, v15
v_lshlrev_b32 v17, 10, v17
v_lshl_add_u32 v17, v18, 8, v17
v_and_b32 v18, 7, v15
v_add_u32 v19, 0, v16
v_lshrrev_b32 v20, 4, v19
v_and_b32 v19, 15, v19
v_xor_b32 v19, v19, v18
v_lshl_add_u32 v19, v19, 4, v17
v_lshl_add_u32 v24, v20, 13, v19
v_add_u32 v19, 1, v16
v_lshrrev_b32 v20, 4, v19
v_and_b32 v19, 15, v19
v_xor_b32 v19, v19, v18
v_lshl_add_u32 v19, v19, 4, v17
v_lshl_add_u32 v25, v20, 13, v19
v_add_u32 v19, 2, v16
v_lshrrev_b32 v20, 4, v19
v_and_b32 v19, 15, v19
v_xor_b32 v19, v19, v18
v_lshl_add_u32 v19, v19, 4, v17
v_lshl_add_u32 v26, v20, 13, v19
v_add_u32 v19, 3, v16
v_lshrrev_b32 v20, 4, v19
v_and_b32 v19, 15, v19
v_xor_b32 v19, v19, v18
v_lshl_add_u32 v19, v19, 4, v17
v_lshl_add_u32 v27, v20, 13, v19
v_add_u32 v19, 4, v16
v_lshrrev_b32 v20, 4, v19
v_and_b32 v19, 15, v19
v_xor_b32 v19, v19, v18
v_lshl_add_u32 v19, v19, 4, v17
v_lshl_add_u32 v28, v20, 13, v19
v_add_u32 v19, 5, v16
v_lshrrev_b32 v20, 4, v19
v_and_b32 v19, 15, v19
v_xor_b32 v19, v19, v18
v_lshl_add_u32 v19, v19, 4, v17
v_lshl_add_u32 v29, v20, 13, v19
v_add_u32 v19, 6, v16
v_lshrrev_b32 v20, 4, v19
v_and_b32 v19, 15, v19
v_xor_b32 v19, v19, v18
v_lshl_add_u32 v19, v19, 4, v17
v_lshl_add_u32 v30, v20, 13, v19
v_xor_b32 v16, v15, v14
v_lshl_add_u32 v16, v14, 4, v16
v_lshlrev_b32 v12, 4, v16
v_xor_b32 v13, 64, v12
v_and_b32 v16, 31, v0
v_lshlrev_b32 v16, 5, v16
s_lshr_b32 s36, s28, 2
s_lshl_b32 s36, s36, 14
s_add_u32 s40, s36, 16777216
v_add_u32 v16, s40, v16
v_and_b32 v17, 7, v0
v_lshlrev_b32 v17, 5, v17
s_lshl_b32 s36, s28, 12
s_add_u32 s41, s36, 16908288
v_add_u32 v17, s41, v17
v_bfe_u32 v19, v0, 3, 1
v_lshl_add_u32 v19, v19, 8, v17
v_cmp_gt_u32 vcc, 32, v0
v_add_u32 v18, 3072, v16
v_add_u32 v19, 256, v19
v_mov_b32 v20, 256
v_mov_b32 v21, 1024
v_cndmask_b32 v10, v19, v18, vcc
v_cndmask_b32 v7, v20, v21, vcc
v_add_u32 v18, 15360, v16
v_add_u32 v19, 3840, v17
v_cndmask_b32 v9, v19, v18, vcc
v_cmp_gt_u32 vcc, 48, v0
v_mov_b32 v18, 0x7f000000
s_nop 0
v_cndmask_b32 v10, v18, v10, vcc
v_cndmask_b32 v9, v18, v9, vcc
v_lshlrev_b32 v18, 5, v0
v_add_u32 v5, s40, v18
v_mov_b32 v8, v17
v_add_u32 v107, 2048, v16
v_cmp_gt_u32 vcc, 32, v0
s_nop 1
v_cndmask_b32 v107, v17, v107, vcc
v_lshlrev_b32 v0, 4, v0
s_lshl_b32 s36, s64, 18
s_add_u32 s36, s36, s39
v_add_u32 v1, s36, v0
v_add_u32 v2, 4096, v1
v_add_u32 v4, 12288, v1
s_mov_b32 s35, 0
s_waitcnt lgkmcnt(0)
s_mul_i32 s65, s65, 0x9E3779B1
s_add_u32 s65, s65, 0x7F4A7C15
v_mov_b32 v108, 0
v_mov_b32 v109, 0
v_mov_b32 v110, 0
v_mov_b32 v111, 0
v_mov_b32 v112, 0
v_mov_b32 v113, 0
v_mov_b32 v114, 0
v_mov_b32 v115, 0
v_mov_b32 v116, 0
v_mov_b32 v117, 0
v_mov_b32 v118, 0
v_mov_b32 v119, 0
v_mov_b32 v120, 0
v_mov_b32 v121, 0
v_mov_b32 v122, 0
v_mov_b32 v123, 0
v_mov_b32 v124, 0
v_mov_b32 v125, 0
v_mov_b32 v126, 0
v_mov_b32 v127, 0
v_mov_b32 v128, 0
v_mov_b32 v129, 0
v_mov_b32 v130, 0
v_mov_b32 v131, 0
v_mov_b32 v132, 0
v_mov_b32 v133, 0
v_mov_b32 v134, 0
v_mov_b32 v135, 0
v_mov_b32 v136, 0
v_mov_b32 v137, 0
v_mov_b32 v138, 0
v_mov_b32 v139, 0
v_mov_b32 v140, 0
v_mov_b32 v141, 0
v_mov_b32 v142, 0
v_mov_b32 v143, 0
v_mov_b32 v144, 0
v_mov_b32 v145, 0
v_mov_b32 v146, 0
v_mov_b32 v147, 0
v_mov_b32 v148, 0
v_mov_b32 v149, 0
v_mov_b32 v150, 0
v_mov_b32 v151, 0
v_mov_b32 v152, 0
v_mov_b32 v153, 0
v_mov_b32 v154, 0
v_mov_b32 v155, 0
v_mov_b32 v156, 0
v_mov_b32 v157, 0
v_mov_b32 v158, 0
v_mov_b32 v159, 0
v_mov_b32 v160, 0
v_mov_b32 v161, 0
v_mov_b32 v162, 0
v_mov_b32 v163, 0
v_mov_b32 v164, 0
v_mov_b32 v165, 0
v_mov_b32 v166, 0
v_mov_b32 v167, 0
v_mov_b32 v168, 0
v_mov_b32 v169, 0
v_mov_b32 v170, 0
v_mov_b32 v171, 0
v_mov_b32 v172, 0
v_mov_b32 v173, 0
v_mov_b32 v174, 0
v_mov_b32 v175, 0
v_mov_b32 v176, 0
v_mov_b32 v177, 0
v_mov_b32 v178, 0
v_mov_b32 v179, 0
v_mov_b32 v180, 0
v_mov_b32 v181, 0
v_mov_b32 v182, 0
v_mov_b32 v183, 0
v_mov_b32 v184, 0
v_mov_b32 v185, 0
v_mov_b32 v186, 0
v_mov_b32 v187, 0
v_mov_b32 v96, 0
v_mov_b32 v97, 0
v_mov_b32 v98, 0
v_mov_b32 v99, 0
v_mov_b32 v100, 0
v_mov_b32 v101, 0xff800000
v_mov_b32 v102, 0xff800000
v_mov_b32 v103, 0xff800000
v_mov_b32 v104, 0xff800000
v_mov_b32 v105, 0xff800000
s_cmp_eq_u32 s64, 0
s_cbranch_scc1 La_norope
s_waitcnt vmcnt(6)
buffer_load_dwordx4 v[52:55], v3, s[12:15], s38 offen offset:1024
buffer_load_dwordx4 v[56:59], v3, s[12:15], s38 offen offset:1280
buffer_load_dwordx4 v[60:63], v3, s[16:19], s37 offen offset:1024
buffer_load_dwordx4 v[64:67], v3, s[16:19], s37 offen offset:1280
buffer_load_dwordx4 v[68:71], v3, s[20:23], s37 offen offset:1024
buffer_load_dwordx4 v[72:75], v3, s[20:23], s37 offen offset:1280
s_cmp_eq_u32 s64, 3
s_cbranch_scc1 La_q0b
v_perm_b32 v36, v192, v188, s5
v_perm_b32 v38, v204, v196, s5
v_perm_b32 v40, v200, v208, s5
v_perm_b32 v37, v192, v188, s6
v_perm_b32 v39, v204, v196, s6
v_perm_b32 v41, v200, v208, s6
v_dot2_f32_bf16 v38, v36, v38, 0 neg_hi:[0,1,0]
v_dot2_f32_bf16 v39, v37, v39, 0 neg_hi:[0,1,0]
v_dot2_f32_bf16 v40, v36, v40, 0
v_dot2_f32_bf16 v41, v37, v41, 0
v_perm_b32 v44, v193, v189, s5
v_perm_b32 v46, v205, v197, s5
v_perm_b32 v48, v201, v209, s5
v_perm_b32 v45, v193, v189, s6
v_perm_b32 v47, v205, v197, s6
v_perm_b32 v49, v201, v209, s6
v_cvt_pk_bf16_f32 v188, v38, v39
v_cvt_pk_bf16_f32 v192, v40, v41
v_dot2_f32_bf16 v46, v44, v46, 0 neg_hi:[0,1,0]
v_dot2_f32_bf16 v47, v45, v47, 0 neg_hi:[0,1,0]
v_dot2_f32_bf16 v48, v44, v48, 0
v_dot2_f32_bf16 v49, v45, v49, 0
v_perm_b32 v36, v194, v190, s5
v_perm_b32 v38, v206, v198, s5
v_perm_b32 v40, v202, v210, s5
v_perm_b32 v37, v194, v190, s6
v_perm_b32 v39, v206, v198, s6
v_perm_b32 v41, v202, v210, s6
v_cvt_pk_bf16_f32 v189, v46, v47
v_cvt_pk_bf16_f32 v193, v48, v49
v_dot2_f32_bf16 v38, v36, v38, 0 neg_hi:[0,1,0]
v_dot2_f32_bf16 v39, v37, v39, 0 neg_hi:[0,1,0]
v_dot2_f32_bf16 v40, v36, v40, 0
v_dot2_f32_bf16 v41, v37, v41, 0
v_perm_b32 v44, v195, v191, s5
v_perm_b32 v46, v207, v199, s5
v_perm_b32 v48, v203, v211, s5
v_perm_b32 v45, v195, v191, s6
v_perm_b32 v47, v207, v199, s6
v_perm_b32 v49, v203, v211, s6
v_cvt_pk_bf16_f32 v190, v38, v39
v_cvt_pk_bf16_f32 v194, v40, v41
v_dot2_f32_bf16 v46, v44, v46, 0 neg_hi:[0,1,0]
v_dot2_f32_bf16 v47, v45, v47, 0 neg_hi:[0,1,0]
v_dot2_f32_bf16 v48, v44, v48, 0
v_dot2_f32_bf16 v49, v45, v49, 0
s_nop 2
v_cvt_pk_bf16_f32 v191, v46, v47
v_cvt_pk_bf16_f32 v195, v48, v49
ds_write_b128 v24, v[188:191]
ds_write_b128 v24, v[192:195] offset:4096
La_q0b:
s_waitcnt vmcnt(6)
buffer_load_dwordx4 v[188:191], v3, s[12:15], s38 offen offset:1536
buffer_load_dwordx4 v[192:195], v3, s[12:15], s38 offen offset:1792
buffer_load_dwordx4 v[196:199], v3, s[16:19], s37 offen offset:1536
buffer_load_dwordx4 v[200:203], v3, s[16:19], s37 offen offset:1792
buffer_load_dwordx4 v[204:207], v3, s[20:23], s37 offen offset:1536
buffer_load_dwordx4 v[208:211], v3, s[20:23], s37 offen offset:1792
v_perm_b32 v36, v216, v212, s5
v_perm_b32 v38, v228, v220, s5
v_perm_b32 v40, v224, v232, s5
v_perm_b32 v37, v216, v212, s6
v_perm_b32 v39, v228, v220, s6
v_perm_b32 v41, v224, v232, s6
v_dot2_f32_bf16 v38, v36, v38, 0 neg_hi:[0,1,0]
v_dot2_f32_bf16 v39, v37, v39, 0 neg_hi:[0,1,0]
v_dot2_f32_bf16 v40, v36, v40, 0
v_dot2_f32_bf16 v41, v37, v41, 0
v_perm_b32 v44, v217, v213, s5
v_perm_b32 v46, v229, v221, s5
v_perm_b32 v48, v225, v233, s5
v_perm_b32 v45, v217, v213, s6
v_perm_b32 v47, v229, v221, s6
v_perm_b32 v49, v225, v233, s6
v_cvt_pk_bf16_f32 v212, v38, v39
v_cvt_pk_bf16_f32 v216, v40, v41
v_dot2_f32_bf16 v46, v44, v46, 0 neg_hi:[0,1,0]
v_dot2_f32_bf16 v47, v45, v47, 0 neg_hi:[0,1,0]
v_dot2_f32_bf16 v48, v44, v48, 0
v_dot2_f32_bf16 v49, v45, v49, 0
v_perm_b32 v36, v218, v214, s5
v_perm_b32 v38, v230, v222, s5
v_perm_b32 v40, v226, v234, s5
v_perm_b32 v37, v218, v214, s6
v_perm_b32 v39, v230, v222, s6
v_perm_b32 v41, v226, v234, s6
v_cvt_pk_bf16_f32 v213, v46, v47
v_cvt_pk_bf16_f32 v217, v48, v49
v_dot2_f32_bf16 v38, v36, v38, 0 neg_hi:[0,1,0]
v_dot2_f32_bf16 v39, v37, v39, 0 neg_hi:[0,1,0]
v_dot2_f32_bf16 v40, v36, v40, 0
v_dot2_f32_bf16 v41, v37, v41, 0
v_perm_b32 v44, v219, v215, s5
v_perm_b32 v46, v231, v223, s5
v_perm_b32 v48, v227, v235, s5
v_perm_b32 v45, v219, v215, s6
v_perm_b32 v47, v231, v223, s6
v_perm_b32 v49, v227, v235, s6
v_cvt_pk_bf16_f32 v214, v38, v39
v_cvt_pk_bf16_f32 v218, v40, v41
v_dot2_f32_bf16 v46, v44, v46, 0 neg_hi:[0,1,0]
v_dot2_f32_bf16 v47, v45, v47, 0 neg_hi:[0,1,0]
v_dot2_f32_bf16 v48, v44, v48, 0
v_dot2_f32_bf16 v49, v45, v49, 0
s_nop 2
v_cvt_pk_bf16_f32 v215, v46, v47
v_cvt_pk_bf16_f32 v219, v48, v49
ds_write_b128 v25, v[212:215]
ds_write_b128 v25, v[216:219] offset:4096
s_waitcnt vmcnt(6)
buffer_load_dwordx4 v[212:215], v3, s[12:15], s38 offen offset:2048
buffer_load_dwordx4 v[216:219], v3, s[12:15], s38 offen offset:2304
buffer_load_dwordx4 v[220:223], v3, s[16:19], s37 offen offset:2048
buffer_load_dwordx4 v[224:227], v3, s[16:19], s37 offen offset:2304
buffer_load_dwordx4 v[228:231], v3, s[20:23], s37 offen offset:2048
buffer_load_dwordx4 v[232:235], v3, s[20:23], s37 offen offset:2304
v_perm_b32 v36, v56, v52, s5
v_perm_b32 v38, v68, v60, s5
v_perm_b32 v40, v64, v72, s5
v_perm_b32 v37, v56, v52, s6
v_perm_b32 v39, v68, v60, s6
v_perm_b32 v41, v64, v72, s6
v_dot2_f32_bf16 v38, v36, v38, 0 neg_hi:[0,1,0]
v_dot2_f32_bf16 v39, v37, v39, 0 neg_hi:[0,1,0]
v_dot2_f32_bf16 v40, v36, v40, 0
v_dot2_f32_bf16 v41, v37, v41, 0
v_perm_b32 v44, v57, v53, s5
v_perm_b32 v46, v69, v61, s5
v_perm_b32 v48, v65, v73, s5
v_perm_b32 v45, v57, v53, s6
v_perm_b32 v47, v69, v61, s6
v_perm_b32 v49, v65, v73, s6
v_cvt_pk_bf16_f32 v52, v38, v39
v_cvt_pk_bf16_f32 v56, v40, v41
v_dot2_f32_bf16 v46, v44, v46, 0 neg_hi:[0,1,0]
v_dot2_f32_bf16 v47, v45, v47, 0 neg_hi:[0,1,0]
v_dot2_f32_bf16 v48, v44, v48, 0
v_dot2_f32_bf16 v49, v45, v49, 0
v_perm_b32 v36, v58, v54, s5
v_perm_b32 v38, v70, v62, s5
v_perm_b32 v40, v66, v74, s5
v_perm_b32 v37, v58, v54, s6
v_perm_b32 v39, v70, v62, s6
v_perm_b32 v41, v66, v74, s6
v_cvt_pk_bf16_f32 v53, v46, v47
v_cvt_pk_bf16_f32 v57, v48, v49
v_dot2_f32_bf16 v38, v36, v38, 0 neg_hi:[0,1,0]
v_dot2_f32_bf16 v39, v37, v39, 0 neg_hi:[0,1,0]
v_dot2_f32_bf16 v40, v36, v40, 0
v_dot2_f32_bf16 v41, v37, v41, 0
v_perm_b32 v44, v59, v55, s5
v_perm_b32 v46, v71, v63, s5
v_perm_b32 v48, v67, v75, s5
v_perm_b32 v45, v59, v55, s6
v_perm_b32 v47, v71, v63, s6
v_perm_b32 v49, v67, v75, s6
v_cvt_pk_bf16_f32 v54, v38, v39
v_cvt_pk_bf16_f32 v58, v40, v41
v_dot2_f32_bf16 v46, v44, v46, 0 neg_hi:[0,1,0]
v_dot2_f32_bf16 v47, v45, v47, 0 neg_hi:[0,1,0]
v_dot2_f32_bf16 v48, v44, v48, 0
v_dot2_f32_bf16 v49, v45, v49, 0
s_nop 2
v_cvt_pk_bf16_f32 v55, v46, v47
v_cvt_pk_bf16_f32 v59, v48, v49
ds_write_b128 v26, v[52:55]
ds_write_b128 v26, v[56:59] offset:4096
s_waitcnt vmcnt(6)
buffer_load_dwordx4 v[52:55], v3, s[12:15], s38 offen offset:2560
buffer_load_dwordx4 v[56:59], v3, s[12:15], s38 offen offset:2816
buffer_load_dwordx4 v[60:63], v3, s[16:19], s37 offen offset:2560
buffer_load_dwordx4 v[64:67], v3, s[16:19], s37 offen offset:2816
buffer_load_dwordx4 v[68:71], v3, s[20:23], s37 offen offset:2560
buffer_load_dwordx4 v[72:75], v3, s[20:23], s37 offen offset:2816
v_perm_b32 v36, v192, v188, s5
v_perm_b32 v38, v204, v196, s5
v_perm_b32 v40, v200, v208, s5
v_perm_b32 v37, v192, v188, s6
v_perm_b32 v39, v204, v196, s6
v_perm_b32 v41, v200, v208, s6
v_dot2_f32_bf16 v38, v36, v38, 0 neg_hi:[0,1,0]
v_dot2_f32_bf16 v39, v37, v39, 0 neg_hi:[0,1,0]
v_dot2_f32_bf16 v40, v36, v40, 0
v_dot2_f32_bf16 v41, v37, v41, 0
v_perm_b32 v44, v193, v189, s5
v_perm_b32 v46, v205, v197, s5
v_perm_b32 v48, v201, v209, s5
v_perm_b32 v45, v193, v189, s6
v_perm_b32 v47, v205, v197, s6
v_perm_b32 v49, v201, v209, s6
v_cvt_pk_bf16_f32 v188, v38, v39
v_cvt_pk_bf16_f32 v192, v40, v41
v_dot2_f32_bf16 v46, v44, v46, 0 neg_hi:[0,1,0]
v_dot2_f32_bf16 v47, v45, v47, 0 neg_hi:[0,1,0]
v_dot2_f32_bf16 v48, v44, v48, 0
v_dot2_f32_bf16 v49, v45, v49, 0
v_perm_b32 v36, v194, v190, s5
v_perm_b32 v38, v206, v198, s5
v_perm_b32 v40, v202, v210, s5
v_perm_b32 v37, v194, v190, s6
v_perm_b32 v39, v206, v198, s6
v_perm_b32 v41, v202, v210, s6
v_cvt_pk_bf16_f32 v189, v46, v47
v_cvt_pk_bf16_f32 v193, v48, v49
v_dot2_f32_bf16 v38, v36, v38, 0 neg_hi:[0,1,0]
v_dot2_f32_bf16 v39, v37, v39, 0 neg_hi:[0,1,0]
v_dot2_f32_bf16 v40, v36, v40, 0
v_dot2_f32_bf16 v41, v37, v41, 0
v_perm_b32 v44, v195, v191, s5
v_perm_b32 v46, v207, v199, s5
v_perm_b32 v48, v203, v211, s5
v_perm_b32 v45, v195, v191, s6
v_perm_b32 v47, v207, v199, s6
v_perm_b32 v49, v203, v211, s6
v_cvt_pk_bf16_f32 v190, v38, v39
v_cvt_pk_bf16_f32 v194, v40, v41
v_dot2_f32_bf16 v46, v44, v46, 0 neg_hi:[0,1,0]
v_dot2_f32_bf16 v47, v45, v47, 0 neg_hi:[0,1,0]
v_dot2_f32_bf16 v48, v44, v48, 0
v_dot2_f32_bf16 v49, v45, v49, 0
s_nop 2
v_cvt_pk_bf16_f32 v191, v46, v47
v_cvt_pk_bf16_f32 v195, v48, v49
ds_write_b128 v27, v[188:191]
ds_write_b128 v27, v[192:195] offset:4096
s_waitcnt vmcnt(6)
buffer_load_dwordx4 v[188:191], v3, s[12:15], s38 offen offset:3072
buffer_load_dwordx4 v[192:195], v3, s[12:15], s38 offen offset:3328
buffer_load_dwordx4 v[196:199], v3, s[16:19], s37 offen offset:3072
buffer_load_dwordx4 v[200:203], v3, s[16:19], s37 offen offset:3328
buffer_load_dwordx4 v[204:207], v3, s[20:23], s37 offen offset:3072
buffer_load_dwordx4 v[208:211], v3, s[20:23], s37 offen offset:3328
v_perm_b32 v36, v216, v212, s5
v_perm_b32 v38, v228, v220, s5
v_perm_b32 v40, v224, v232, s5
v_perm_b32 v37, v216, v212, s6
v_perm_b32 v39, v228, v220, s6
v_perm_b32 v41, v224, v232, s6
v_dot2_f32_bf16 v38, v36, v38, 0 neg_hi:[0,1,0]
v_dot2_f32_bf16 v39, v37, v39, 0 neg_hi:[0,1,0]
v_dot2_f32_bf16 v40, v36, v40, 0
v_dot2_f32_bf16 v41, v37, v41, 0
v_perm_b32 v44, v217, v213, s5
v_perm_b32 v46, v229, v221, s5
v_perm_b32 v48, v225, v233, s5
v_perm_b32 v45, v217, v213, s6
v_perm_b32 v47, v229, v221, s6
v_perm_b32 v49, v225, v233, s6
v_cvt_pk_bf16_f32 v212, v38, v39
v_cvt_pk_bf16_f32 v216, v40, v41
v_dot2_f32_bf16 v46, v44, v46, 0 neg_hi:[0,1,0]
v_dot2_f32_bf16 v47, v45, v47, 0 neg_hi:[0,1,0]
v_dot2_f32_bf16 v48, v44, v48, 0
v_dot2_f32_bf16 v49, v45, v49, 0
v_perm_b32 v36, v218, v214, s5
v_perm_b32 v38, v230, v222, s5
v_perm_b32 v40, v226, v234, s5
v_perm_b32 v37, v218, v214, s6
v_perm_b32 v39, v230, v222, s6
v_perm_b32 v41, v226, v234, s6
v_cvt_pk_bf16_f32 v213, v46, v47
v_cvt_pk_bf16_f32 v217, v48, v49
v_dot2_f32_bf16 v38, v36, v38, 0 neg_hi:[0,1,0]
v_dot2_f32_bf16 v39, v37, v39, 0 neg_hi:[0,1,0]
v_dot2_f32_bf16 v40, v36, v40, 0
v_dot2_f32_bf16 v41, v37, v41, 0
v_perm_b32 v44, v219, v215, s5
v_perm_b32 v46, v231, v223, s5
v_perm_b32 v48, v227, v235, s5
v_perm_b32 v45, v219, v215, s6
v_perm_b32 v47, v231, v223, s6
v_perm_b32 v49, v227, v235, s6
v_cvt_pk_bf16_f32 v214, v38, v39
v_cvt_pk_bf16_f32 v218, v40, v41
v_dot2_f32_bf16 v46, v44, v46, 0 neg_hi:[0,1,0]
v_dot2_f32_bf16 v47, v45, v47, 0 neg_hi:[0,1,0]
v_dot2_f32_bf16 v48, v44, v48, 0
v_dot2_f32_bf16 v49, v45, v49, 0
s_nop 2
v_cvt_pk_bf16_f32 v215, v46, v47
v_cvt_pk_bf16_f32 v219, v48, v49
ds_write_b128 v28, v[212:215]
ds_write_b128 v28, v[216:219] offset:4096
s_waitcnt vmcnt(6)
v_perm_b32 v36, v56, v52, s5
v_perm_b32 v38, v68, v60, s5
v_perm_b32 v40, v64, v72, s5
v_perm_b32 v37, v56, v52, s6
v_perm_b32 v39, v68, v60, s6
v_perm_b32 v41, v64, v72, s6
v_dot2_f32_bf16 v38, v36, v38, 0 neg_hi:[0,1,0]
v_dot2_f32_bf16 v39, v37, v39, 0 neg_hi:[0,1,0]
v_dot2_f32_bf16 v40, v36, v40, 0
v_dot2_f32_bf16 v41, v37, v41, 0
v_perm_b32 v44, v57, v53, s5
v_perm_b32 v46, v69, v61, s5
v_perm_b32 v48, v65, v73, s5
v_perm_b32 v45, v57, v53, s6
v_perm_b32 v47, v69, v61, s6
v_perm_b32 v49, v65, v73, s6
v_cvt_pk_bf16_f32 v52, v38, v39
v_cvt_pk_bf16_f32 v56, v40, v41
v_dot2_f32_bf16 v46, v44, v46, 0 neg_hi:[0,1,0]
v_dot2_f32_bf16 v47, v45, v47, 0 neg_hi:[0,1,0]
v_dot2_f32_bf16 v48, v44, v48, 0
v_dot2_f32_bf16 v49, v45, v49, 0
v_perm_b32 v36, v58, v54, s5
v_perm_b32 v38, v70, v62, s5
v_perm_b32 v40, v66, v74, s5
v_perm_b32 v37, v58, v54, s6
v_perm_b32 v39, v70, v62, s6
v_perm_b32 v41, v66, v74, s6
v_cvt_pk_bf16_f32 v53, v46, v47
v_cvt_pk_bf16_f32 v57, v48, v49
v_dot2_f32_bf16 v38, v36, v38, 0 neg_hi:[0,1,0]
v_dot2_f32_bf16 v39, v37, v39, 0 neg_hi:[0,1,0]
v_dot2_f32_bf16 v40, v36, v40, 0
v_dot2_f32_bf16 v41, v37, v41, 0
v_perm_b32 v44, v59, v55, s5
v_perm_b32 v46, v71, v63, s5
v_perm_b32 v48, v67, v75, s5
v_perm_b32 v45, v59, v55, s6
v_perm_b32 v47, v71, v63, s6
v_perm_b32 v49, v67, v75, s6
v_cvt_pk_bf16_f32 v54, v38, v39
v_cvt_pk_bf16_f32 v58, v40, v41
v_dot2_f32_bf16 v46, v44, v46, 0 neg_hi:[0,1,0]
v_dot2_f32_bf16 v47, v45, v47, 0 neg_hi:[0,1,0]
v_dot2_f32_bf16 v48, v44, v48, 0
v_dot2_f32_bf16 v49, v45, v49, 0
s_nop 2
v_cvt_pk_bf16_f32 v55, v46, v47
v_cvt_pk_bf16_f32 v59, v48, v49
ds_write_b128 v29, v[52:55]
ds_write_b128 v29, v[56:59] offset:4096
s_waitcnt vmcnt(0)
v_perm_b32 v36, v192, v188, s5
v_perm_b32 v38, v204, v196, s5
v_perm_b32 v40, v200, v208, s5
v_perm_b32 v37, v192, v188, s6
v_perm_b32 v39, v204, v196, s6
v_perm_b32 v41, v200, v208, s6
v_dot2_f32_bf16 v38, v36, v38, 0 neg_hi:[0,1,0]
v_dot2_f32_bf16 v39, v37, v39, 0 neg_hi:[0,1,0]
v_dot2_f32_bf16 v40, v36, v40, 0
v_dot2_f32_bf16 v41, v37, v41, 0
v_perm_b32 v44, v193, v189, s5
v_perm_b32 v46, v205, v197, s5
v_perm_b32 v48, v201, v209, s5
v_perm_b32 v45, v193, v189, s6
v_perm_b32 v47, v205, v197, s6
v_perm_b32 v49, v201, v209, s6
v_cvt_pk_bf16_f32 v188, v38, v39
v_cvt_pk_bf16_f32 v192, v40, v41
v_dot2_f32_bf16 v46, v44, v46, 0 neg_hi:[0,1,0]
v_dot2_f32_bf16 v47, v45, v47, 0 neg_hi:[0,1,0]
v_dot2_f32_bf16 v48, v44, v48, 0
v_dot2_f32_bf16 v49, v45, v49, 0
v_perm_b32 v36, v194, v190, s5
v_perm_b32 v38, v206, v198, s5
v_perm_b32 v40, v202, v210, s5
v_perm_b32 v37, v194, v190, s6
v_perm_b32 v39, v206, v198, s6
v_perm_b32 v41, v202, v210, s6
v_cvt_pk_bf16_f32 v189, v46, v47
v_cvt_pk_bf16_f32 v193, v48, v49
v_dot2_f32_bf16 v38, v36, v38, 0 neg_hi:[0,1,0]
v_dot2_f32_bf16 v39, v37, v39, 0 neg_hi:[0,1,0]
v_dot2_f32_bf16 v40, v36, v40, 0
v_dot2_f32_bf16 v41, v37, v41, 0
v_perm_b32 v44, v195, v191, s5
v_perm_b32 v46, v207, v199, s5
v_perm_b32 v48, v203, v211, s5
v_perm_b32 v45, v195, v191, s6
v_perm_b32 v47, v207, v199, s6
v_perm_b32 v49, v203, v211, s6
v_cvt_pk_bf16_f32 v190, v38, v39
v_cvt_pk_bf16_f32 v194, v40, v41
v_dot2_f32_bf16 v46, v44, v46, 0 neg_hi:[0,1,0]
v_dot2_f32_bf16 v47, v45, v47, 0 neg_hi:[0,1,0]
v_dot2_f32_bf16 v48, v44, v48, 0
v_dot2_f32_bf16 v49, v45, v49, 0
s_nop 2
v_cvt_pk_bf16_f32 v191, v46, v47
v_cvt_pk_bf16_f32 v195, v48, v49
ds_write_b128 v30, v[188:191]
ds_write_b128 v30, v[192:195] offset:4096
La_norope:
v_add_u32 v3, 8192, v1
s_waitcnt lgkmcnt(0)
s_barrier
buffer_load_dword v6, v5, s[8:11], 0 offen sc1
ds_read_b128 a[0:3], v12 offset:0
ds_read_b128 a[32:35], v12 offset:8192
ds_read_b128 a[64:67], v12 offset:16384
ds_read_b128 a[96:99], v12 offset:24576
ds_read_b128 a[128:131], v12 offset:32768
ds_read_b128 a[4:7], v13 offset:1024
ds_read_b128 a[36:39], v13 offset:9216
ds_read_b128 a[68:71], v13 offset:17408
ds_read_b128 a[100:103], v13 offset:25600
ds_read_b128 a[132:135], v13 offset:33792
ds_read_b128 a[8:11], v12 offset:2048
ds_read_b128 a[40:43], v12 offset:10240
ds_read_b128 a[72:75], v12 offset:18432
ds_read_b128 a[104:107], v12 offset:26624
ds_read_b128 a[136:139], v12 offset:34816
ds_read_b128 a[12:15], v13 offset:3072
ds_read_b128 a[44:47], v13 offset:11264
ds_read_b128 a[76:79], v13 offset:19456
ds_read_b128 a[108:111], v13 offset:27648
ds_read_b128 a[140:143], v13 offset:35840
ds_read_b128 a[16:19], v12 offset:4096
ds_read_b128 a[48:51], v12 offset:12288
ds_read_b128 a[80:83], v12 offset:20480
ds_read_b128 a[112:115], v12 offset:28672
ds_read_b128 a[144:147], v12 offset:36864
ds_read_b128 a[20:23], v13 offset:5120
ds_read_b128 a[52:55], v13 offset:13312
ds_read_b128 a[84:87], v13 offset:21504
ds_read_b128 a[116:119], v13 offset:29696
ds_read_b128 a[148:151], v13 offset:37888
ds_read_b128 a[24:27], v12 offset:6144
ds_read_b128 a[56:59], v12 offset:14336
ds_read_b128 a[88:91], v12 offset:22528
ds_read_b128 a[120:123], v12 offset:30720
ds_read_b128 a[152:155], v12 offset:38912
ds_read_b128 a[28:31], v13 offset:7168
ds_read_b128 a[60:63], v13 offset:15360
ds_read_b128 a[92:95], v13 offset:23552
ds_read_b128 a[124:127], v13 offset:31744
ds_read_b128 a[156:159], v13 offset:39936
s_mov_b32 s36, 0x20000
s_waitcnt vmcnt(0)
La_w0:
v_cmp_ne_u32 vcc, s65, v6
s_sub_u32 s36, s36, 1
s_cbranch_scc1 La_w0_ok
s_and_b64 s[44:45], vcc, -1
s_cbranch_scc0 La_w0_ok
s_sleep 3
buffer_load_dword v6, v5, s[8:11], 0 offen sc1
s_waitcnt vmcnt(0)
s_branch La_w0
La_w0_ok:
s_mov_b32 s31, 0
s_mov_b32 s32, 8388608
buffer_load_dwordx4 a[160:163], v1, s[8:11], s31 offen offset:0 sc1
buffer_load_dwordx4 a[164:167], v1, s[8:11], s31 offen offset:1024 sc1
buffer_load_dwordx4 a[168:171], v1, s[8:11], s31 offen offset:2048 sc1
buffer_load_dwordx4 a[172:175], v1, s[8:11], s31 offen offset:3072 sc1
buffer_load_dwordx4 a[176:179], v2, s[8:11], s31 offen offset:0 sc1
buffer_load_dwordx4 a[180:183], v2, s[8:11], s31 offen offset:1024 sc1
buffer_load_dwordx4 a[184:187], v2, s[8:11], s31 offen offset:2048 sc1
buffer_load_dwordx4 a[188:191], v2, s[8:11], s31 offen offset:3072 sc1
buffer_load_dwordx4 a[192:195], v3, s[8:11], s31 offen offset:0 sc1
buffer_load_dwordx4 a[196:199], v3, s[8:11], s31 offen offset:1024 sc1
buffer_load_dwordx4 a[200:203], v3, s[8:11], s31 offen offset:2048 sc1
buffer_load_dwordx4 a[204:207], v3, s[8:11], s31 offen offset:3072 sc1
buffer_load_dwordx4 a[208:211], v4, s[8:11], s31 offen offset:0 sc1
buffer_load_dwordx4 a[212:215], v4, s[8:11], s31 offen offset:1024 sc1
buffer_load_dwordx4 a[216:219], v4, s[8:11], s31 offen offset:2048 sc1
buffer_load_dwordx4 a[220:223], v4, s[8:11], s31 offen offset:3072 sc1
s_add_u32 s31, s31, 16384
s_cmp_lg_u32 s64, 0
s_cbranch_scc1 La_noalive
s_lshl_b32 s36, s2, 5
s_add_u32 s36, s36, 17039360
v_mov_b32 v16, s65
s_mov_b64 exec, 1
buffer_store_dword v16, v0, s[8:11], s36 offen sc1
s_mov_b64 exec, -1
La_noalive:
v_mov_b32 v16, 0xc1400000
v_mov_b32 v17, 0xc1400000
v_mov_b32 v18, 0xc1400000
v_mov_b32 v19, 0xc1400000
v_mov_b32 v20, 0xc1400000
v_mov_b32 v21, 0xc1400000
v_mov_b32 v22, 0xc1400000
v_mov_b32 v23, 0xc1400000
v_mov_b32 v24, 0xc1400000
v_mov_b32 v25, 0xc1400000
v_mov_b32 v26, 0xc1400000
v_mov_b32 v27, 0xc1400000
v_mov_b32 v28, 0xc1400000
v_mov_b32 v29, 0xc1400000
v_mov_b32 v30, 0xc1400000
v_mov_b32 v31, 0xc1400000
v_mov_b32 v32, 0xc1400000
v_mov_b32 v33, 0xc1400000
v_mov_b32 v34, 0xc1400000
v_mov_b32 v35, 0xc1400000
s_branch La_go
La_restart:
v_mov_b32 v108, 0
v_mov_b32 v109, 0
v_mov_b32 v110, 0
v_mov_b32 v111, 0
v_mov_b32 v112, 0
v_mov_b32 v113, 0
v_mov_b32 v114, 0
v_mov_b32 v115, 0
v_mov_b32 v116, 0
v_mov_b32 v117, 0
v_mov_b32 v118, 0
v_mov_b32 v119, 0
v_mov_b32 v120, 0
v_mov_b32 v121, 0
v_mov_b32 v122, 0
v_mov_b32 v123, 0
v_mov_b32 v124, 0
v_mov_b32 v125, 0
v_mov_b32 v126, 0
v_mov_b32 v127, 0
v_mov_b32 v128, 0
v_mov_b32 v129, 0
v_mov_b32 v130, 0
v_mov_b32 v131, 0
v_mov_b32 v132, 0
v_mov_b32 v133, 0
v_mov_b32 v134, 0
v_mov_b32 v135, 0
v_mov_b32 v136, 0
v_mov_b32 v137, 0
v_mov_b32 v138, 0
v_mov_b32 v139, 0
v_mov_b32 v140, 0
v_mov_b32 v141, 0
v_mov_b32 v142, 0
v_mov_b32 v143, 0
v_mov_b32 v144, 0
v_mov_b32 v145, 0
v_mov_b32 v146, 0
v_mov_b32 v147, 0
v_mov_b32 v148, 0
v_mov_b32 v149, 0
v_mov_b32 v150, 0
v_mov_b32 v151, 0
v_mov_b32 v152, 0
v_mov_b32 v153, 0
v_mov_b32 v154, 0
v_mov_b32 v155, 0
v_mov_b32 v156, 0
v_mov_b32 v157, 0
v_mov_b32 v158, 0
v_mov_b32 v159, 0
v_mov_b32 v160, 0
v_mov_b32 v161, 0
v_mov_b32 v162, 0
v_mov_b32 v163, 0
v_mov_b32 v164, 0
v_mov_b32 v165, 0
v_mov_b32 v166, 0
v_mov_b32 v167, 0
v_mov_b32 v168, 0
v_mov_b32 v169, 0
v_mov_b32 v170, 0
v_mov_b32 v171, 0
v_mov_b32 v172, 0
v_mov_b32 v173, 0
v_mov_b32 v174, 0
v_mov_b32 v175, 0
v_mov_b32 v176, 0
v_mov_b32 v177, 0
v_mov_b32 v178, 0
v_mov_b32 v179, 0
v_mov_b32 v180, 0
v_mov_b32 v181, 0
v_mov_b32 v182, 0
v_mov_b32 v183, 0
v_mov_b32 v184, 0
v_mov_b32 v185, 0
v_mov_b32 v186, 0
v_mov_b32 v187, 0
v_mov_b32 v96, 0
v_mov_b32 v97, 0
v_mov_b32 v98, 0
v_mov_b32 v99, 0
v_mov_b32 v100, 0
La_go:
s_waitcnt lgkmcnt(0)
s_barrier
s_mul_i32 s36, s64, 5120
v_add_u32 v12, s36, v0
v_mov_b32 v13, v0
v_mov_b32 v5, v10
s_waitcnt vmcnt(14) lgkmcnt(0)
v_mfma_f32_16x16x32_bf16 v[36:39], a[160:163], a[0:3], v[16:19]
v_mfma_f32_16x16x32_bf16 v[36:39], a[164:167], a[4:7], v[36:39]
v_mfma_f32_16x16x32_bf16 v[40:43], a[164:167], a[36:39], v[20:23]
v_mfma_f32_16x16x32_bf16 v[40:43], a[160:163], a[32:35], v[40:43]
v_mfma_f32_16x16x32_bf16 v[44:47], a[160:163], a[64:67], v[24:27]
v_mfma_f32_16x16x32_bf16 v[44:47], a[164:167], a[68:71], v[44:47]
v_mfma_f32_16x16x32_bf16 v[48:51], a[164:167], a[100:103], v[28:31]
v_mfma_f32_16x16x32_bf16 v[48:51], a[160:163], a[96:99], v[48:51]
v_mfma_f32_16x16x32_bf16 v[52:55], a[160:163], a[128:131], v[32:35]
v_mfma_f32_16x16x32_bf16 v[52:55], a[164:167], a[132:135], v[52:55]
s_waitcnt vmcnt(12)
v_mfma_f32_16x16x32_bf16 v[36:39], a[168:171], a[8:11], v[36:39]
buffer_load_dwordx4 a[160:163], v1, s[8:11], s31 offen offset:0 sc1
v_mfma_f32_16x16x32_bf16 v[36:39], a[172:175], a[12:15], v[36:39]
v_mfma_f32_16x16x32_bf16 v[40:43], a[172:175], a[44:47], v[40:43]
v_mfma_f32_16x16x32_bf16 v[40:43], a[168:171], a[40:43], v[40:43]
v_mfma_f32_16x16x32_bf16 v[44:47], a[168:171], a[72:75], v[44:47]
v_mfma_f32_16x16x32_bf16 v[44:47], a[172:175], a[76:79], v[44:47]
buffer_load_dwordx4 a[164:167], v1, s[8:11], s31 offen offset:1024 sc1
v_mfma_f32_16x16x32_bf16 v[48:51], a[172:175], a[108:111], v[48:51]
v_mfma_f32_16x16x32_bf16 v[48:51], a[168:171], a[104:107], v[48:51]
v_mfma_f32_16x16x32_bf16 v[52:55], a[168:171], a[136:139], v[52:55]
v_mfma_f32_16x16x32_bf16 v[52:55], a[172:175], a[140:143], v[52:55]
s_waitcnt vmcnt(12)
v_mfma_f32_16x16x32_bf16 v[36:39], a[176:179], a[16:19], v[36:39]
buffer_load_dwordx4 a[168:171], v1, s[8:11], s31 offen offset:2048 sc1
v_mfma_f32_16x16x32_bf16 v[36:39], a[180:183], a[20:23], v[36:39]
v_mfma_f32_16x16x32_bf16 v[40:43], a[180:183], a[52:55], v[40:43]
v_mfma_f32_16x16x32_bf16 v[40:43], a[176:179], a[48:51], v[40:43]
v_mfma_f32_16x16x32_bf16 v[44:47], a[176:179], a[80:83], v[44:47]
v_mfma_f32_16x16x32_bf16 v[44:47], a[180:183], a[84:87], v[44:47]
buffer_load_dwordx4 a[172:175], v1, s[8:11], s31 offen offset:3072 sc1
v_mfma_f32_16x16x32_bf16 v[48:51], a[180:183], a[116:119], v[48:51]
v_mfma_f32_16x16x32_bf16 v[48:51], a[176:179], a[112:115], v[48:51]
v_mfma_f32_16x16x32_bf16 v[52:55], a[176:179], a[144:147], v[52:55]
v_mfma_f32_16x16x32_bf16 v[52:55], a[180:183], a[148:151], v[52:55]
s_waitcnt vmcnt(12)
v_mfma_f32_16x16x32_bf16 v[36:39], a[184:187], a[24:27], v[36:39]
buffer_load_dwordx4 a[176:179], v2, s[8:11], s31 offen offset:0 sc1
v_mfma_f32_16x16x32_bf16 v[36:39], a[188:191], a[28:31], v[36:39]
v_mfma_f32_16x16x32_bf16 v[40:43], a[188:191], a[60:63], v[40:43]
v_mfma_f32_16x16x32_bf16 v[40:43], a[184:187], a[56:59], v[40:43]
v_mfma_f32_16x16x32_bf16 v[44:47], a[184:187], a[88:91], v[44:47]
v_mfma_f32_16x16x32_bf16 v[44:47], a[188:191], a[92:95], v[44:47]
buffer_load_dwordx4 a[180:183], v2, s[8:11], s31 offen offset:1024 sc1
v_mfma_f32_16x16x32_bf16 v[48:51], a[188:191], a[124:127], v[48:51]
v_mfma_f32_16x16x32_bf16 v[48:51], a[184:187], a[120:123], v[48:51]
v_mfma_f32_16x16x32_bf16 v[52:55], a[184:187], a[152:155], v[52:55]
v_exp_f32 v36, v36
v_mfma_f32_16x16x32_bf16 v[52:55], a[188:191], a[156:159], v[52:55]
v_add_f32 v96, v96, v36
s_waitcnt vmcnt(12)
v_mfma_f32_16x16x32_bf16 v[56:59], a[192:195], a[0:3], v[16:19]
buffer_load_dwordx4 a[184:187], v2, s[8:11], s31 offen offset:2048 sc1
v_mfma_f32_16x16x32_bf16 v[56:59], a[196:199], a[4:7], v[56:59]
v_exp_f32 v37, v37
v_mfma_f32_16x16x32_bf16 v[60:63], a[196:199], a[36:39], v[20:23]
v_exp_f32 v38, v38
v_mfma_f32_16x16x32_bf16 v[60:63], a[192:195], a[32:35], v[60:63]
v_exp_f32 v39, v39
v_mfma_f32_16x16x32_bf16 v[64:67], a[192:195], a[64:67], v[24:27]
v_exp_f32 v40, v40
v_mfma_f32_16x16x32_bf16 v[64:67], a[196:199], a[68:71], v[64:67]
buffer_load_dwordx4 a[188:191], v2, s[8:11], s31 offen offset:3072 sc1
v_mfma_f32_16x16x32_bf16 v[68:71], a[196:199], a[100:103], v[28:31]
v_exp_f32 v41, v41
v_mfma_f32_16x16x32_bf16 v[68:71], a[192:195], a[96:99], v[68:71]
v_exp_f32 v42, v42
v_mfma_f32_16x16x32_bf16 v[72:75], a[192:195], a[128:131], v[32:35]
v_exp_f32 v43, v43
v_mfma_f32_16x16x32_bf16 v[72:75], a[196:199], a[132:135], v[72:75]
v_add_f32 v96, v96, v37
s_waitcnt vmcnt(12)
v_mfma_f32_16x16x32_bf16 v[56:59], a[200:203], a[8:11], v[56:59]
buffer_load_dwordx4 a[192:195], v3, s[8:11], s31 offen offset:0 sc1
v_mfma_f32_16x16x32_bf16 v[56:59], a[204:207], a[12:15], v[56:59]
v_exp_f32 v44, v44
v_mfma_f32_16x16x32_bf16 v[60:63], a[204:207], a[44:47], v[60:63]
v_exp_f32 v45, v45
v_mfma_f32_16x16x32_bf16 v[60:63], a[200:203], a[40:43], v[60:63]
v_exp_f32 v46, v46
v_mfma_f32_16x16x32_bf16 v[64:67], a[200:203], a[72:75], v[64:67]
v_exp_f32 v47, v47
v_mfma_f32_16x16x32_bf16 v[64:67], a[204:207], a[76:79], v[64:67]
buffer_load_dwordx4 a[196:199], v3, s[8:11], s31 offen offset:1024 sc1
v_mfma_f32_16x16x32_bf16 v[68:71], a[204:207], a[108:111], v[68:71]
v_exp_f32 v48, v48
v_mfma_f32_16x16x32_bf16 v[68:71], a[200:203], a[104:107], v[68:71]
v_exp_f32 v49, v49
v_mfma_f32_16x16x32_bf16 v[72:75], a[200:203], a[136:139], v[72:75]
v_exp_f32 v50, v50
v_mfma_f32_16x16x32_bf16 v[72:75], a[204:207], a[140:143], v[72:75]
v_cvt_pk_bf16_f32 v76, v36, v37
s_waitcnt vmcnt(12)
v_mfma_f32_16x16x32_bf16 v[56:59], a[208:211], a[16:19], v[56:59]
buffer_load_dwordx4 a[200:203], v3, s[8:11], s31 offen offset:2048 sc1
v_mfma_f32_16x16x32_bf16 v[56:59], a[212:215], a[20:23], v[56:59]
v_exp_f32 v51, v51
v_mfma_f32_16x16x32_bf16 v[60:63], a[212:215], a[52:55], v[60:63]
v_exp_f32 v52, v52
buffer_load_dword v6, v107, s[8:11], 0 offen sc1
v_mfma_f32_16x16x32_bf16 v[60:63], a[208:211], a[48:51], v[60:63]
v_exp_f32 v53, v53
v_mfma_f32_16x16x32_bf16 v[64:67], a[208:211], a[80:83], v[64:67]
v_exp_f32 v54, v54
v_mfma_f32_16x16x32_bf16 v[64:67], a[212:215], a[84:87], v[64:67]
buffer_load_dwordx4 a[204:207], v3, s[8:11], s31 offen offset:3072 sc1
v_mfma_f32_16x16x32_bf16 v[68:71], a[212:215], a[116:119], v[68:71]
v_exp_f32 v55, v55
v_mfma_f32_16x16x32_bf16 v[68:71], a[208:211], a[112:115], v[68:71]
v_add_f32 v96, v96, v38
v_add_f32 v96, v96, v39
v_mfma_f32_16x16x32_bf16 v[72:75], a[208:211], a[144:147], v[72:75]
v_cvt_pk_bf16_f32 v77, v38, v39
v_add_f32 v97, v97, v40
v_mfma_f32_16x16x32_bf16 v[72:75], a[212:215], a[148:151], v[72:75]
v_add_f32 v97, v97, v41
s_waitcnt vmcnt(13)
v_mfma_f32_16x16x32_bf16 v[56:59], a[216:219], a[24:27], v[56:59]
buffer_load_dwordx4 a[208:211], v4, s[8:11], s31 offen offset:0 sc1
v_mfma_f32_16x16x32_bf16 v[56:59], a[220:223], a[28:31], v[56:59]
ds_write_b64 v12, v[76:77] offset:0
v_mfma_f32_16x16x32_bf16 v[60:63], a[220:223], a[60:63], v[60:63]
v_cvt_pk_bf16_f32 v80, v40, v41
v_add_f32 v97, v97, v42
v_mfma_f32_16x16x32_bf16 v[60:63], a[216:219], a[56:59], v[60:63]
v_add_f32 v97, v97, v43
v_cvt_pk_bf16_f32 v81, v42, v43
v_mfma_f32_16x16x32_bf16 v[64:67], a[216:219], a[88:91], v[64:67]
ds_write_b64 v12, v[80:81] offset:1024
v_mfma_f32_16x16x32_bf16 v[64:67], a[220:223], a[92:95], v[64:67]
buffer_load_dwordx4 a[212:215], v4, s[8:11], s31 offen offset:1024 sc1
v_mfma_f32_16x16x32_bf16 v[68:71], a[220:223], a[124:127], v[68:71]
v_add_f32 v98, v98, v44
v_add_f32 v98, v98, v45
v_mfma_f32_16x16x32_bf16 v[68:71], a[216:219], a[120:123], v[68:71]
v_cvt_pk_bf16_f32 v84, v44, v45
v_add_f32 v98, v98, v46
v_mfma_f32_16x16x32_bf16 v[72:75], a[216:219], a[152:155], v[72:75]
v_add_f32 v98, v98, v47
v_cvt_pk_bf16_f32 v85, v46, v47
v_mfma_f32_16x16x32_bf16 v[72:75], a[220:223], a[156:159], v[72:75]
v_add_f32 v99, v99, v48
s_nop 4
ds_write_b64 v12, v[84:85] offset:2048
v_add_f32 v99, v99, v49
v_cvt_pk_bf16_f32 v88, v48, v49
v_add_f32 v99, v99, v50
v_add_f32 v99, v99, v51
v_cvt_pk_bf16_f32 v89, v50, v51
ds_write_b64 v12, v[88:89] offset:3072
v_add_f32 v100, v100, v52
v_add_f32 v100, v100, v53
v_cvt_pk_bf16_f32 v92, v52, v53
v_add_f32 v100, v100, v54
v_add_f32 v100, v100, v55
v_cvt_pk_bf16_f32 v93, v54, v55
ds_write_b64 v12, v[92:93] offset:4096
v_exp_f32 v56, v56
v_exp_f32 v57, v57
v_exp_f32 v58, v58
v_exp_f32 v59, v59
v_add_f32 v96, v96, v56
v_add_f32 v96, v96, v57
v_cvt_pk_bf16_f32 v78, v56, v57
v_add_f32 v96, v96, v58
v_add_f32 v96, v96, v59
v_cvt_pk_bf16_f32 v79, v58, v59
ds_write_b64 v12, v[78:79] offset:8
v_exp_f32 v60, v60
v_exp_f32 v61, v61
v_exp_f32 v62, v62
v_exp_f32 v63, v63
v_add_f32 v97, v97, v60
v_add_f32 v97, v97, v61
s_nop 0
s_mov_b32 s36, 0x20000
s_waitcnt vmcnt(3)
La_w3:
v_cmp_ne_u32 vcc, s65, v6
s_sub_u32 s36, s36, 1
s_cbranch_scc1 La_w3_ok
s_and_b64 s[44:45], vcc, -1
s_cbranch_scc0 La_w3_ok
s_sleep 3
buffer_load_dword v6, v107, s[8:11], 0 offen sc1
s_waitcnt vmcnt(0)
s_branch La_w3
La_w3_ok:
v_mfma_f32_16x16x32_bf16 v[36:39], a[160:163], a[0:3], v[16:19]
buffer_load_dwordx4 a[216:219], v4, s[8:11], s31 offen offset:2048 sc1
v_mfma_f32_16x16x32_bf16 v[36:39], a[164:167], a[4:7], v[36:39]
v_cvt_pk_bf16_f32 v82, v60, v61
v_add_f32 v97, v97, v62
v_mfma_f32_16x16x32_bf16 v[40:43], a[164:167], a[36:39], v[20:23]
v_exp_f32 v64, v64
v_mfma_f32_16x16x32_bf16 v[40:43], a[160:163], a[32:35], v[40:43]
v_exp_f32 v65, v65
v_mfma_f32_16x16x32_bf16 v[44:47], a[160:163], a[64:67], v[24:27]
v_exp_f32 v66, v66
v_mfma_f32_16x16x32_bf16 v[44:47], a[164:167], a[68:71], v[44:47]
buffer_load_dwordx4 a[220:223], v4, s[8:11], s31 offen offset:3072 sc1
v_mfma_f32_16x16x32_bf16 v[48:51], a[164:167], a[100:103], v[28:31]
s_add_u32 s31, s31, 16384
v_add_f32 v97, v97, v63
v_mfma_f32_16x16x32_bf16 v[48:51], a[160:163], a[96:99], v[48:51]
v_exp_f32 v67, v67
v_mfma_f32_16x16x32_bf16 v[52:55], a[160:163], a[128:131], v[32:35]
v_exp_f32 v68, v68
v_mfma_f32_16x16x32_bf16 v[52:55], a[164:167], a[132:135], v[52:55]
v_cvt_pk_bf16_f32 v83, v62, v63
s_waitcnt vmcnt(12)
v_mfma_f32_16x16x32_bf16 v[36:39], a[168:171], a[8:11], v[36:39]
buffer_load_dwordx4 a[160:163], v1, s[8:11], s31 offen offset:0 sc1
v_mfma_f32_16x16x32_bf16 v[36:39], a[172:175], a[12:15], v[36:39]
ds_write_b64 v12, v[82:83] offset:1032
v_mfma_f32_16x16x32_bf16 v[40:43], a[172:175], a[44:47], v[40:43]
v_exp_f32 v69, v69
v_mfma_f32_16x16x32_bf16 v[40:43], a[168:171], a[40:43], v[40:43]
v_exp_f32 v70, v70
v_mfma_f32_16x16x32_bf16 v[44:47], a[168:171], a[72:75], v[44:47]
v_exp_f32 v71, v71
v_mfma_f32_16x16x32_bf16 v[44:47], a[172:175], a[76:79], v[44:47]
buffer_load_dwordx4 a[164:167], v1, s[8:11], s31 offen offset:1024 sc1
v_mfma_f32_16x16x32_bf16 v[48:51], a[172:175], a[108:111], v[48:51]
v_exp_f32 v72, v72
v_mfma_f32_16x16x32_bf16 v[48:51], a[168:171], a[104:107], v[48:51]
v_exp_f32 v73, v73
v_mfma_f32_16x16x32_bf16 v[52:55], a[168:171], a[136:139], v[52:55]
v_exp_f32 v74, v74
v_mfma_f32_16x16x32_bf16 v[52:55], a[172:175], a[140:143], v[52:55]
v_add_f32 v98, v98, v64
s_waitcnt vmcnt(12)
v_mfma_f32_16x16x32_bf16 v[36:39], a[176:179], a[16:19], v[36:39]
buffer_load_dwordx4 a[168:171], v1, s[8:11], s31 offen offset:2048 sc1
v_mfma_f32_16x16x32_bf16 v[36:39], a[180:183], a[20:23], v[36:39]
v_exp_f32 v75, v75
v_mfma_f32_16x16x32_bf16 v[40:43], a[180:183], a[52:55], v[40:43]
v_add_f32 v98, v98, v65
v_cvt_pk_bf16_f32 v86, v64, v65
v_mfma_f32_16x16x32_bf16 v[40:43], a[176:179], a[48:51], v[40:43]
v_add_f32 v98, v98, v66
v_add_f32 v98, v98, v67
v_mfma_f32_16x16x32_bf16 v[44:47], a[176:179], a[80:83], v[44:47]
v_cvt_pk_bf16_f32 v87, v66, v67
v_add_f32 v99, v99, v68
v_mfma_f32_16x16x32_bf16 v[44:47], a[180:183], a[84:87], v[44:47]
buffer_load_dwordx4 a[172:175], v1, s[8:11], s31 offen offset:3072 sc1
v_mfma_f32_16x16x32_bf16 v[48:51], a[180:183], a[116:119], v[48:51]
ds_write_b64 v12, v[86:87] offset:2056
v_mfma_f32_16x16x32_bf16 v[48:51], a[176:179], a[112:115], v[48:51]
v_add_f32 v99, v99, v69
v_cvt_pk_bf16_f32 v90, v68, v69
v_mfma_f32_16x16x32_bf16 v[52:55], a[176:179], a[144:147], v[52:55]
v_add_f32 v99, v99, v70
v_add_f32 v99, v99, v71
v_mfma_f32_16x16x32_bf16 v[52:55], a[180:183], a[148:151], v[52:55]
v_cvt_pk_bf16_f32 v91, v70, v71
s_waitcnt vmcnt(12)
v_mfma_f32_16x16x32_bf16 v[36:39], a[184:187], a[24:27], v[36:39]
buffer_load_dwordx4 a[176:179], v2, s[8:11], s31 offen offset:0 sc1
v_mfma_f32_16x16x32_bf16 v[36:39], a[188:191], a[28:31], v[36:39]
ds_write_b64 v12, v[90:91] offset:3080
v_mfma_f32_16x16x32_bf16 v[40:43], a[188:191], a[60:63], v[40:43]
v_add_f32 v100, v100, v72
v_add_f32 v100, v100, v73
v_mfma_f32_16x16x32_bf16 v[40:43], a[184:187], a[56:59], v[40:43]
v_cvt_pk_bf16_f32 v94, v72, v73
v_add_f32 v100, v100, v74
v_mfma_f32_16x16x32_bf16 v[44:47], a[184:187], a[88:91], v[44:47]
v_add_f32 v100, v100, v75
v_cvt_pk_bf16_f32 v95, v74, v75
v_mfma_f32_16x16x32_bf16 v[44:47], a[188:191], a[92:95], v[44:47]
buffer_load_dwordx4 a[180:183], v2, s[8:11], s31 offen offset:1024 sc1
v_mfma_f32_16x16x32_bf16 v[48:51], a[188:191], a[124:127], v[48:51]
ds_write_b64 v12, v[94:95] offset:4104
v_mfma_f32_16x16x32_bf16 v[48:51], a[184:187], a[120:123], v[48:51]
v_add_u32 v12, 0x8000, v12
v_and_b32 v12, 0x1ffff, v12
v_mfma_f32_16x16x32_bf16 v[52:55], a[184:187], a[152:155], v[52:55]
v_exp_f32 v36, v36
v_mfma_f32_16x16x32_bf16 v[52:55], a[188:191], a[156:159], v[52:55]
v_add_f32 v96, v96, v36
s_waitcnt vmcnt(12)
v_mfma_f32_16x16x32_bf16 v[56:59], a[192:195], a[0:3], v[16:19]
buffer_load_dwordx4 a[184:187], v2, s[8:11], s31 offen offset:2048 sc1
v_mfma_f32_16x16x32_bf16 v[56:59], a[196:199], a[4:7], v[56:59]
v_exp_f32 v37, v37
v_mfma_f32_16x16x32_bf16 v[60:63], a[196:199], a[36:39], v[20:23]
v_exp_f32 v38, v38
v_mfma_f32_16x16x32_bf16 v[60:63], a[192:195], a[32:35], v[60:63]
v_exp_f32 v39, v39
v_mfma_f32_16x16x32_bf16 v[64:67], a[192:195], a[64:67], v[24:27]
v_exp_f32 v40, v40
v_mfma_f32_16x16x32_bf16 v[64:67], a[196:199], a[68:71], v[64:67]
buffer_load_dwordx4 a[188:191], v2, s[8:11], s31 offen offset:3072 sc1
v_mfma_f32_16x16x32_bf16 v[68:71], a[196:199], a[100:103], v[28:31]
v_exp_f32 v41, v41
v_mfma_f32_16x16x32_bf16 v[68:71], a[192:195], a[96:99], v[68:71]
v_exp_f32 v42, v42
v_mfma_f32_16x16x32_bf16 v[72:75], a[192:195], a[128:131], v[32:35]
v_exp_f32 v43, v43
v_mfma_f32_16x16x32_bf16 v[72:75], a[196:199], a[132:135], v[72:75]
v_add_f32 v96, v96, v37
s_waitcnt vmcnt(12)
v_mfma_f32_16x16x32_bf16 v[56:59], a[200:203], a[8:11], v[56:59]
buffer_load_dwordx4 a[192:195], v3, s[8:11], s31 offen offset:0 sc1
v_mfma_f32_16x16x32_bf16 v[56:59], a[204:207], a[12:15], v[56:59]
v_exp_f32 v44, v44
v_mfma_f32_16x16x32_bf16 v[60:63], a[204:207], a[44:47], v[60:63]
v_exp_f32 v45, v45
v_mfma_f32_16x16x32_bf16 v[60:63], a[200:203], a[40:43], v[60:63]
v_exp_f32 v46, v46
v_mfma_f32_16x16x32_bf16 v[64:67], a[200:203], a[72:75], v[64:67]
v_exp_f32 v47, v47
v_mfma_f32_16x16x32_bf16 v[64:67], a[204:207], a[76:79], v[64:67]
buffer_load_dwordx4 a[196:199], v3, s[8:11], s31 offen offset:1024 sc1
v_mfma_f32_16x16x32_bf16 v[68:71], a[204:207], a[108:111], v[68:71]
v_exp_f32 v48, v48
v_mfma_f32_16x16x32_bf16 v[68:71], a[200:203], a[104:107], v[68:71]
v_exp_f32 v49, v49
v_mfma_f32_16x16x32_bf16 v[72:75], a[200:203], a[136:139], v[72:75]
v_exp_f32 v50, v50
v_mfma_f32_16x16x32_bf16 v[72:75], a[204:207], a[140:143], v[72:75]
v_cvt_pk_bf16_f32 v76, v36, v37
s_waitcnt vmcnt(12)
v_mfma_f32_16x16x32_bf16 v[56:59], a[208:211], a[16:19], v[56:59]
buffer_load_dwordx4 a[200:203], v3, s[8:11], s31 offen offset:2048 sc1
v_mfma_f32_16x16x32_bf16 v[56:59], a[212:215], a[20:23], v[56:59]
v_exp_f32 v51, v51
v_mfma_f32_16x16x32_bf16 v[60:63], a[212:215], a[52:55], v[60:63]
v_exp_f32 v52, v52
v_mfma_f32_16x16x32_bf16 v[60:63], a[208:211], a[48:51], v[60:63]
v_exp_f32 v53, v53
v_mfma_f32_16x16x32_bf16 v[64:67], a[208:211], a[80:83], v[64:67]
v_exp_f32 v54, v54
v_mfma_f32_16x16x32_bf16 v[64:67], a[212:215], a[84:87], v[64:67]
buffer_load_dwordx4 a[204:207], v3, s[8:11], s31 offen offset:3072 sc1
v_mfma_f32_16x16x32_bf16 v[68:71], a[212:215], a[116:119], v[68:71]
v_exp_f32 v55, v55
v_mfma_f32_16x16x32_bf16 v[68:71], a[208:211], a[112:115], v[68:71]
v_add_f32 v96, v96, v38
v_add_f32 v96, v96, v39
v_mfma_f32_16x16x32_bf16 v[72:75], a[208:211], a[144:147], v[72:75]
v_cvt_pk_bf16_f32 v77, v38, v39
v_add_f32 v97, v97, v40
v_mfma_f32_16x16x32_bf16 v[72:75], a[212:215], a[148:151], v[72:75]
v_add_f32 v97, v97, v41
s_waitcnt vmcnt(12)
v_mfma_f32_16x16x32_bf16 v[56:59], a[216:219], a[24:27], v[56:59]
buffer_load_dwordx4 a[208:211], v4, s[8:11], s31 offen offset:0 sc1
v_mfma_f32_16x16x32_bf16 v[56:59], a[220:223], a[28:31], v[56:59]
ds_write_b64 v12, v[76:77] offset:0
v_mfma_f32_16x16x32_bf16 v[60:63], a[220:223], a[60:63], v[60:63]
v_cvt_pk_bf16_f32 v80, v40, v41
v_add_f32 v97, v97, v42
v_mfma_f32_16x16x32_bf16 v[60:63], a[216:219], a[56:59], v[60:63]
v_add_f32 v97, v97, v43
v_cvt_pk_bf16_f32 v81, v42, v43
v_mfma_f32_16x16x32_bf16 v[64:67], a[216:219], a[88:91], v[64:67]
ds_write_b64 v12, v[80:81] offset:1024
v_mfma_f32_16x16x32_bf16 v[64:67], a[220:223], a[92:95], v[64:67]
buffer_load_dwordx4 a[212:215], v4, s[8:11], s31 offen offset:1024 sc1
v_mfma_f32_16x16x32_bf16 v[68:71], a[220:223], a[124:127], v[68:71]
v_add_f32 v98, v98, v44
v_add_f32 v98, v98, v45
v_mfma_f32_16x16x32_bf16 v[68:71], a[216:219], a[120:123], v[68:71]
v_cvt_pk_bf16_f32 v84, v44, v45
v_add_f32 v98, v98, v46
v_mfma_f32_16x16x32_bf16 v[72:75], a[216:219], a[152:155], v[72:75]
v_add_f32 v98, v98, v47
v_cvt_pk_bf16_f32 v85, v46, v47
v_mfma_f32_16x16x32_bf16 v[72:75], a[220:223], a[156:159], v[72:75]
v_add_f32 v99, v99, v48
s_waitcnt vmcnt(12)
s_nop 4
ds_write_b64 v12, v[84:85] offset:2048
v_add_f32 v99, v99, v49
v_cvt_pk_bf16_f32 v88, v48, v49
v_add_f32 v99, v99, v50
v_add_f32 v99, v99, v51
v_cvt_pk_bf16_f32 v89, v50, v51
ds_write_b64 v12, v[88:89] offset:3072
v_add_f32 v100, v100, v52
v_add_f32 v100, v100, v53
v_cvt_pk_bf16_f32 v92, v52, v53
v_add_f32 v100, v100, v54
v_add_f32 v100, v100, v55
v_cvt_pk_bf16_f32 v93, v54, v55
ds_write_b64 v12, v[92:93] offset:4096
v_exp_f32 v56, v56
v_exp_f32 v57, v57
v_exp_f32 v58, v58
v_exp_f32 v59, v59
v_add_f32 v96, v96, v56
v_add_f32 v96, v96, v57
v_cvt_pk_bf16_f32 v78, v56, v57
v_add_f32 v96, v96, v58
v_add_f32 v96, v96, v59
v_cvt_pk_bf16_f32 v79, v58, v59
v_exp_f32 v60, v60
v_exp_f32 v61, v61
v_exp_f32 v62, v62
v_exp_f32 v63, v63
v_add_f32 v97, v97, v60
v_add_f32 v97, v97, v61
v_cvt_pk_bf16_f32 v82, v60, v61
v_add_f32 v97, v97, v62
v_add_f32 v97, v97, v63
v_cvt_pk_bf16_f32 v83, v62, v63
v_exp_f32 v64, v64
v_exp_f32 v65, v65
v_exp_f32 v66, v66
v_exp_f32 v67, v67
v_exp_f32 v68, v68
v_exp_f32 v69, v69
v_exp_f32 v70, v70
v_exp_f32 v71, v71
v_exp_f32 v72, v72
v_exp_f32 v73, v73
v_exp_f32 v74, v74
v_exp_f32 v75, v75
s_nop 0
v_mov_b32 v6, s65
s_mov_b32 s56, s8
s_mov_b32 s57, s9
s_mov_b32 s59, 0x00020000
s_cmp_eq_u32 s64, 0
s_cselect_b32 s58, 17825792, 0
s_cselect_b32 s42, -1, 0
s_cselect_b32 s46, 0xff, 0
s_cselect_b32 s47, 0xffff, 0
s_mov_b32 s34, 14
s_waitcnt lgkmcnt(0)
s_barrier
ds_read_b128 a[224:227], v13 offset:0
ds_read_b128 a[228:231], v13 offset:1024
ds_read_b128 a[232:235], v13 offset:2048
ds_read_b128 a[236:239], v13 offset:3072
ds_read_b128 a[240:243], v13 offset:4096
ds_read_b128 a[244:247], v13 offset:5120
ds_read_b128 a[248:251], v13 offset:6144
ds_read_b128 a[252:255], v13 offset:7168
ds_read_b128 v[188:191], v13 offset:8192
ds_read_b128 v[192:195], v13 offset:9216
s_branch La_loop
.p2align 6
La_loop:
v_mfma_f32_16x16x32_bf16 v[36:39], a[160:163], a[0:3], v[16:19]
buffer_load_dwordx4 a[216:219], v4, s[8:11], s31 offen offset:2048 sc1
v_mfma_f32_16x16x32_bf16 v[36:39], a[164:167], a[4:7], v[36:39]
v_add_f32 v98, v98, v64
v_add_f32 v98, v98, v65
v_mfma_f32_16x16x32_bf16 v[40:43], a[164:167], a[36:39], v[20:23]
buffer_load_dword v6, v5, s[56:59], 0 offen sc1
v_mfma_f32_16x16x32_bf16 v[40:43], a[160:163], a[32:35], v[40:43]
v_cvt_pk_bf16_f32 v86, v64, v65
v_add_f32 v98, v98, v66
v_mfma_f32_16x16x32_bf16 v[44:47], a[160:163], a[64:67], v[24:27]
v_add_f32 v98, v98, v67
v_cvt_pk_bf16_f32 v87, v66, v67
v_mfma_f32_16x16x32_bf16 v[44:47], a[164:167], a[68:71], v[44:47]
buffer_load_dwordx4 a[220:223], v4, s[8:11], s31 offen offset:3072 sc1
v_mfma_f32_16x16x32_bf16 v[48:51], a[164:167], a[100:103], v[28:31]
v_add_f32 v99, v99, v68
v_add_f32 v99, v99, v69
v_mfma_f32_16x16x32_bf16 v[48:51], a[160:163], a[96:99], v[48:51]
v_cvt_pk_bf16_f32 v90, v68, v69
v_add_f32 v99, v99, v70
v_mfma_f32_16x16x32_bf16 v[52:55], a[160:163], a[128:131], v[32:35]
v_add_f32 v99, v99, v71
v_cvt_pk_bf16_f32 v91, v70, v71
v_mfma_f32_16x16x32_bf16 v[52:55], a[164:167], a[132:135], v[52:55]
v_add_f32 v100, v100, v72
s_waitcnt vmcnt(13)
v_mfma_f32_16x16x32_bf16 v[36:39], a[168:171], a[8:11], v[36:39]
buffer_load_dwordx4 a[160:163], v1, s[8:11], s32 offen offset:0 sc1
v_mfma_f32_16x16x32_bf16 v[36:39], a[172:175], a[12:15], v[36:39]
v_add_f32 v100, v100, v73
v_cvt_pk_bf16_f32 v94, v72, v73
v_mfma_f32_16x16x32_bf16 v[40:43], a[172:175], a[44:47], v[40:43]
ds_write_b64 v12, v[78:79] offset:8
v_mfma_f32_16x16x32_bf16 v[40:43], a[168:171], a[40:43], v[40:43]
v_add_f32 v100, v100, v74
v_add_f32 v100, v100, v75
v_mfma_f32_16x16x32_bf16 v[44:47], a[168:171], a[72:75], v[44:47]
v_cvt_pk_bf16_f32 v95, v74, v75
v_mfma_f32_16x16x32_bf16 v[44:47], a[172:175], a[76:79], v[44:47]
buffer_load_dwordx4 a[164:167], v1, s[8:11], s32 offen offset:1024 sc1
v_mfma_f32_16x16x32_bf16 v[48:51], a[172:175], a[108:111], v[48:51]
v_mfma_f32_16x16x32_bf16 v[48:51], a[168:171], a[104:107], v[48:51]
ds_write_b64 v12, v[82:83] offset:1032
v_mfma_f32_16x16x32_bf16 v[52:55], a[168:171], a[136:139], v[52:55]
v_mfma_f32_16x16x32_bf16 v[52:55], a[172:175], a[140:143], v[52:55]
s_waitcnt vmcnt(13)
v_mfma_f32_16x16x32_bf16 v[36:39], a[176:179], a[16:19], v[36:39]
buffer_load_dwordx4 a[168:171], v1, s[8:11], s32 offen offset:2048 sc1
v_mfma_f32_16x16x32_bf16 v[36:39], a[180:183], a[20:23], v[36:39]
v_mfma_f32_16x16x32_bf16 v[40:43], a[180:183], a[52:55], v[40:43]
ds_write_b64 v12, v[86:87] offset:2056
v_mfma_f32_16x16x32_bf16 v[40:43], a[176:179], a[48:51], v[40:43]
v_mfma_f32_16x16x32_bf16 v[44:47], a[176:179], a[80:83], v[44:47]
v_mfma_f32_16x16x32_bf16 v[44:47], a[180:183], a[84:87], v[44:47]
buffer_load_dwordx4 a[172:175], v1, s[8:11], s32 offen offset:3072 sc1
v_mfma_f32_16x16x32_bf16 v[48:51], a[180:183], a[116:119], v[48:51]
s_cmp_eq_u32 s34, 1
s_cselect_b32 s43, s47, s46
v_mfma_f32_16x16x32_bf16 v[48:51], a[176:179], a[112:115], v[48:51]
ds_write_b64 v12, v[90:91] offset:3080
v_mfma_f32_16x16x32_bf16 v[52:55], a[176:179], a[144:147], v[52:55]
v_mfma_f32_16x16x32_bf16 v[52:55], a[180:183], a[148:151], v[52:55]
s_waitcnt vmcnt(13)
v_mfma_f32_16x16x32_bf16 v[36:39], a[184:187], a[24:27], v[36:39]
buffer_load_dwordx4 a[176:179], v2, s[8:11], s32 offen offset:0 sc1
v_mfma_f32_16x16x32_bf16 v[36:39], a[188:191], a[28:31], v[36:39]
v_mfma_f32_16x16x32_bf16 v[40:43], a[188:191], a[60:63], v[40:43]
ds_write_b64 v12, v[94:95] offset:4104
v_mfma_f32_16x16x32_bf16 v[40:43], a[184:187], a[56:59], v[40:43]
v_add_u32 v12, 0x8000, v12
v_and_b32 v12, 0x1ffff, v12
v_mfma_f32_16x16x32_bf16 v[44:47], a[184:187], a[88:91], v[44:47]
v_mfma_f32_16x16x32_bf16 v[44:47], a[188:191], a[92:95], v[44:47]
buffer_load_dwordx4 a[180:183], v2, s[8:11], s32 offen offset:1024 sc1
v_mfma_f32_16x16x32_bf16 v[48:51], a[188:191], a[124:127], v[48:51]
v_mfma_f32_16x16x32_bf16 v[48:51], a[184:187], a[120:123], v[48:51]
s_add_u32 s31, s31, 16384
v_mfma_f32_16x16x32_bf16 v[52:55], a[184:187], a[152:155], v[52:55]
v_exp_f32 v36, v36
v_mfma_f32_16x16x32_bf16 v[52:55], a[188:191], a[156:159], v[52:55]
s_waitcnt vmcnt(13)
v_mfma_f32_16x16x32_bf16 v[56:59], a[192:195], a[0:3], v[16:19]
buffer_load_dwordx4 a[184:187], v2, s[8:11], s32 offen offset:2048 sc1
v_mfma_f32_16x16x32_bf16 v[56:59], a[196:199], a[4:7], v[56:59]
v_exp_f32 v37, v37
v_mfma_f32_16x16x32_bf16 v[60:63], a[196:199], a[36:39], v[20:23]
v_exp_f32 v38, v38
v_mfma_f32_16x16x32_bf16 v[60:63], a[192:195], a[32:35], v[60:63]
v_exp_f32 v39, v39
v_mfma_f32_16x16x32_bf16 v[64:67], a[192:195], a[64:67], v[24:27]
v_exp_f32 v40, v40
v_mfma_f32_16x16x32_bf16 v[64:67], a[196:199], a[68:71], v[64:67]
buffer_load_dwordx4 a[188:191], v2, s[8:11], s32 offen offset:3072 sc1
v_mfma_f32_16x16x32_bf16 v[68:71], a[196:199], a[100:103], v[28:31]
v_exp_f32 v41, v41
v_mfma_f32_16x16x32_bf16 v[68:71], a[192:195], a[96:99], v[68:71]
v_exp_f32 v42, v42
v_mfma_f32_16x16x32_bf16 v[72:75], a[192:195], a[128:131], v[32:35]
v_exp_f32 v43, v43
v_mfma_f32_16x16x32_bf16 v[72:75], a[196:199], a[132:135], v[72:75]
v_add_f32 v96, v96, v36
s_waitcnt vmcnt(13)
v_mfma_f32_16x16x32_bf16 v[56:59], a[200:203], a[8:11], v[56:59]
buffer_load_dwordx4 a[192:195], v3, s[8:11], s32 offen offset:0 sc1
v_mfma_f32_16x16x32_bf16 v[56:59], a[204:207], a[12:15], v[56:59]
v_exp_f32 v44, v44
v_mfma_f32_16x16x32_bf16 v[60:63], a[204:207], a[44:47], v[60:63]
v_exp_f32 v45, v45
v_mfma_f32_16x16x32_bf16 v[60:63], a[200:203], a[40:43], v[60:63]
v_exp_f32 v46, v46
v_mfma_f32_16x16x32_bf16 v[64:67], a[200:203], a[72:75], v[64:67]
v_exp_f32 v47, v47
v_mfma_f32_16x16x32_bf16 v[64:67], a[204:207], a[76:79], v[64:67]
buffer_load_dwordx4 a[196:199], v3, s[8:11], s32 offen offset:1024 sc1
v_mfma_f32_16x16x32_bf16 v[68:71], a[204:207], a[108:111], v[68:71]
v_exp_f32 v48, v48
v_mfma_f32_16x16x32_bf16 v[68:71], a[200:203], a[104:107], v[68:71]
v_exp_f32 v49, v49
v_mfma_f32_16x16x32_bf16 v[72:75], a[200:203], a[136:139], v[72:75]
v_exp_f32 v50, v50
v_mfma_f32_16x16x32_bf16 v[72:75], a[204:207], a[140:143], v[72:75]
v_add_f32 v96, v96, v37
s_waitcnt vmcnt(13)
v_mfma_f32_16x16x32_bf16 v[56:59], a[208:211], a[16:19], v[56:59]
buffer_load_dwordx4 a[200:203], v3, s[8:11], s32 offen offset:2048 sc1
v_mfma_f32_16x16x32_bf16 v[56:59], a[212:215], a[20:23], v[56:59]
v_exp_f32 v51, v51
v_mfma_f32_16x16x32_bf16 v[60:63], a[212:215], a[52:55], v[60:63]
v_exp_f32 v52, v52
v_mfma_f32_16x16x32_bf16 v[60:63], a[208:211], a[48:51], v[60:63]
v_exp_f32 v53, v53
v_mfma_f32_16x16x32_bf16 v[64:67], a[208:211], a[80:83], v[64:67]
v_exp_f32 v54, v54
v_mfma_f32_16x16x32_bf16 v[64:67], a[212:215], a[84:87], v[64:67]
buffer_load_dwordx4 a[204:207], v3, s[8:11], s32 offen offset:3072 sc1
v_mfma_f32_16x16x32_bf16 v[68:71], a[212:215], a[116:119], v[68:71]
v_exp_f32 v55, v55
v_mfma_f32_16x16x32_bf16 v[68:71], a[208:211], a[112:115], v[68:71]
v_cvt_pk_bf16_f32 v76, v36, v37
v_add_f32 v96, v96, v38
v_mfma_f32_16x16x32_bf16 v[72:75], a[208:211], a[144:147], v[72:75]
v_add_f32 v96, v96, v39
v_cvt_pk_bf16_f32 v77, v38, v39
v_mfma_f32_16x16x32_bf16 v[72:75], a[212:215], a[148:151], v[72:75]
v_add_f32 v97, v97, v40
s_waitcnt vmcnt(12)
v_mfma_f32_16x16x32_bf16 v[56:59], a[216:219], a[24:27], v[56:59]
buffer_load_dwordx4 a[208:211], v4, s[8:11], s32 offen offset:0 sc1
v_mfma_f32_16x16x32_bf16 v[56:59], a[220:223], a[28:31], v[56:59]
v_add_f32 v97, v97, v41
v_cvt_pk_bf16_f32 v80, v40, v41
v_mfma_f32_16x16x32_bf16 v[60:63], a[220:223], a[60:63], v[60:63]
v_add_f32 v97, v97, v42
v_add_f32 v97, v97, v43
v_mfma_f32_16x16x32_bf16 v[60:63], a[216:219], a[56:59], v[60:63]
v_cvt_pk_bf16_f32 v81, v42, v43
v_add_f32 v98, v98, v44
v_mfma_f32_16x16x32_bf16 v[64:67], a[216:219], a[88:91], v[64:67]
v_add_f32 v98, v98, v45
v_cvt_pk_bf16_f32 v84, v44, v45
v_mfma_f32_16x16x32_bf16 v[64:67], a[220:223], a[92:95], v[64:67]
buffer_load_dwordx4 a[212:215], v4, s[8:11], s32 offen offset:1024 sc1
v_mfma_f32_16x16x32_bf16 v[68:71], a[220:223], a[124:127], v[68:71]
v_cmp_ne_u32 vcc, s65, v6
v_add_f32 v98, v98, v46
v_mfma_f32_16x16x32_bf16 v[68:71], a[216:219], a[120:123], v[68:71]
s_and_b64 s[44:45], vcc, s[42:43]
s_cbranch_scc1 La_late
La_cont:
v_mfma_f32_16x16x32_bf16 v[72:75], a[216:219], a[152:155], v[72:75]
v_add_f32 v98, v98, v47
v_cvt_pk_bf16_f32 v85, v46, v47
v_mfma_f32_16x16x32_bf16 v[72:75], a[220:223], a[156:159], v[72:75]
s_waitcnt vmcnt(12) lgkmcnt(0)
s_barrier
v_mfma_f32_16x16x32_bf16 v[108:111], a[224:227], a[160:163], v[108:111]
buffer_load_dwordx4 a[216:219], v4, s[8:11], s32 offen offset:2048 sc1
v_mfma_f32_16x16x32_bf16 v[108:111], a[244:247], a[164:167], v[108:111]
v_add_f32 v99, v99, v48
v_add_f32 v99, v99, v49
v_mfma_f32_16x16x32_bf16 v[112:115], a[248:251], a[164:167], v[112:115]
v_cvt_pk_bf16_f32 v88, v48, v49
v_add_f32 v99, v99, v50
v_mfma_f32_16x16x32_bf16 v[112:115], a[228:231], a[160:163], v[112:115]
v_add_f32 v99, v99, v51
v_cvt_pk_bf16_f32 v89, v50, v51
v_mfma_f32_16x16x32_bf16 v[116:119], a[232:235], a[160:163], v[116:119]
v_add_f32 v100, v100, v52
v_add_f32 v100, v100, v53
v_mfma_f32_16x16x32_bf16 v[116:119], a[252:255], a[164:167], v[116:119]
buffer_load_dwordx4 a[220:223], v4, s[8:11], s32 offen offset:3072 sc1
v_mfma_f32_16x16x32_bf16 v[120:123], v[188:191], a[164:167], v[120:123]
s_add_u32 s32, s32, 16384
s_cmp_eq_u32 s34, 1
v_mfma_f32_16x16x32_bf16 v[120:123], a[236:239], a[160:163], v[120:123]
s_cselect_b32 s31, s32, s31
v_cvt_pk_bf16_f32 v92, v52, v53
v_mfma_f32_16x16x32_bf16 v[124:127], a[240:243], a[160:163], v[124:127]
v_add_f32 v100, v100, v54
v_add_f32 v100, v100, v55
v_mfma_f32_16x16x32_bf16 v[124:127], v[192:195], a[164:167], v[124:127]
ds_read_b128 v[196:199], v13 offset:10240
s_waitcnt vmcnt(12)
v_mfma_f32_16x16x32_bf16 v[128:131], a[224:227], a[168:171], v[128:131]
buffer_load_dwordx4 a[160:163], v1, s[8:11], s31 offen offset:0 sc1
v_mfma_f32_16x16x32_bf16 v[128:131], a[244:247], a[172:175], v[128:131]
v_cvt_pk_bf16_f32 v93, v54, v55
v_mfma_f32_16x16x32_bf16 v[132:135], a[248:251], a[172:175], v[132:135]
ds_write_b64 v12, v[76:77] offset:0
v_mfma_f32_16x16x32_bf16 v[132:135], a[228:231], a[168:171], v[132:135]
ds_read_b128 v[200:203], v13 offset:11264
v_mfma_f32_16x16x32_bf16 v[136:139], a[232:235], a[168:171], v[136:139]
ds_read_b128 v[204:207], v13 offset:12288
v_mfma_f32_16x16x32_bf16 v[136:139], a[252:255], a[172:175], v[136:139]
buffer_load_dwordx4 a[164:167], v1, s[8:11], s31 offen offset:1024 sc1
v_mfma_f32_16x16x32_bf16 v[140:143], v[188:191], a[172:175], v[140:143]
v_mfma_f32_16x16x32_bf16 v[140:143], a[236:239], a[168:171], v[140:143]
ds_write_b64 v12, v[80:81] offset:1024
v_mfma_f32_16x16x32_bf16 v[144:147], a[240:243], a[168:171], v[144:147]
ds_read_b128 v[208:211], v13 offset:13312
v_mfma_f32_16x16x32_bf16 v[144:147], v[192:195], a[172:175], v[144:147]
ds_read_b128 v[212:215], v13 offset:14336
s_waitcnt vmcnt(12)
v_mfma_f32_16x16x32_bf16 v[148:151], a[224:227], a[176:179], v[148:151]
buffer_load_dwordx4 a[168:171], v1, s[8:11], s31 offen offset:2048 sc1
v_mfma_f32_16x16x32_bf16 v[148:151], a[244:247], a[180:183], v[148:151]
v_mfma_f32_16x16x32_bf16 v[152:155], a[248:251], a[180:183], v[152:155]
ds_write_b64 v12, v[84:85] offset:2048
v_mfma_f32_16x16x32_bf16 v[152:155], a[228:231], a[176:179], v[152:155]
ds_read_b128 v[216:219], v13 offset:15360
v_mfma_f32_16x16x32_bf16 v[156:159], a[232:235], a[176:179], v[156:159]
ds_read_b128 v[220:223], v13 offset:16384
v_mfma_f32_16x16x32_bf16 v[156:159], a[252:255], a[180:183], v[156:159]
buffer_load_dwordx4 a[172:175], v1, s[8:11], s31 offen offset:3072 sc1
v_mfma_f32_16x16x32_bf16 v[160:163], v[188:191], a[180:183], v[160:163]
v_mfma_f32_16x16x32_bf16 v[160:163], a[236:239], a[176:179], v[160:163]
ds_write_b64 v12, v[88:89] offset:3072
v_mfma_f32_16x16x32_bf16 v[164:167], a[240:243], a[176:179], v[164:167]
ds_read_b128 v[224:227], v13 offset:17408
v_mfma_f32_16x16x32_bf16 v[164:167], v[192:195], a[180:183], v[164:167]
ds_read_b128 v[228:231], v13 offset:18432
s_waitcnt vmcnt(12)
v_mfma_f32_16x16x32_bf16 v[168:171], a[224:227], a[184:187], v[168:171]
buffer_load_dwordx4 a[176:179], v2, s[8:11], s31 offen offset:0 sc1
v_mfma_f32_16x16x32_bf16 v[168:171], a[244:247], a[188:191], v[168:171]
v_mfma_f32_16x16x32_bf16 v[172:175], a[248:251], a[188:191], v[172:175]
ds_write_b64 v12, v[92:93] offset:4096
v_mfma_f32_16x16x32_bf16 v[172:175], a[228:231], a[184:187], v[172:175]
ds_read_b128 v[232:235], v13 offset:19456
v_mfma_f32_16x16x32_bf16 v[176:179], a[232:235], a[184:187], v[176:179]
v_add_u32 v5, v7, v5
v_min_u32 v5, v9, v5
v_mfma_f32_16x16x32_bf16 v[176:179], a[252:255], a[188:191], v[176:179]
buffer_load_dwordx4 a[180:183], v2, s[8:11], s31 offen offset:1024 sc1
v_mfma_f32_16x16x32_bf16 v[180:183], v[188:191], a[188:191], v[180:183]
v_add_u32 v13, 0x8000, v13
v_and_b32 v13, 0x1ffff, v13
v_mfma_f32_16x16x32_bf16 v[180:183], a[236:239], a[184:187], v[180:183]
v_mfma_f32_16x16x32_bf16 v[184:187], a[240:243], a[184:187], v[184:187]
v_exp_f32 v56, v56
v_mfma_f32_16x16x32_bf16 v[184:187], v[192:195], a[188:191], v[184:187]
s_sub_u32 s34, s34, 1
s_waitcnt vmcnt(12) lgkmcnt(0)
v_mfma_f32_16x16x32_bf16 v[108:111], v[196:199], a[192:195], v[108:111]
buffer_load_dwordx4 a[184:187], v2, s[8:11], s31 offen offset:2048 sc1
v_mfma_f32_16x16x32_bf16 v[108:111], v[216:219], a[196:199], v[108:111]
v_exp_f32 v57, v57
v_mfma_f32_16x16x32_bf16 v[112:115], v[220:223], a[196:199], v[112:115]
v_exp_f32 v58, v58
v_mfma_f32_16x16x32_bf16 v[112:115], v[200:203], a[192:195], v[112:115]
v_exp_f32 v59, v59
v_mfma_f32_16x16x32_bf16 v[116:119], v[204:207], a[192:195], v[116:119]
v_exp_f32 v60, v60
v_mfma_f32_16x16x32_bf16 v[116:119], v[224:227], a[196:199], v[116:119]
buffer_load_dwordx4 a[188:191], v2, s[8:11], s31 offen offset:3072 sc1
v_mfma_f32_16x16x32_bf16 v[120:123], v[228:231], a[196:199], v[120:123]
v_exp_f32 v61, v61
v_mfma_f32_16x16x32_bf16 v[120:123], v[208:211], a[192:195], v[120:123]
v_exp_f32 v62, v62
v_mfma_f32_16x16x32_bf16 v[124:127], v[212:215], a[192:195], v[124:127]
v_exp_f32 v63, v63
v_mfma_f32_16x16x32_bf16 v[124:127], v[232:235], a[196:199], v[124:127]
ds_read_b128 a[224:227], v13 offset:0
s_waitcnt vmcnt(12)
v_mfma_f32_16x16x32_bf16 v[128:131], v[196:199], a[200:203], v[128:131]
buffer_load_dwordx4 a[192:195], v3, s[8:11], s31 offen offset:0 sc1
v_mfma_f32_16x16x32_bf16 v[128:131], v[216:219], a[204:207], v[128:131]
v_exp_f32 v64, v64
v_mfma_f32_16x16x32_bf16 v[132:135], v[220:223], a[204:207], v[132:135]
v_exp_f32 v65, v65
v_mfma_f32_16x16x32_bf16 v[132:135], v[200:203], a[200:203], v[132:135]
v_exp_f32 v66, v66
v_mfma_f32_16x16x32_bf16 v[136:139], v[204:207], a[200:203], v[136:139]
v_exp_f32 v67, v67
v_mfma_f32_16x16x32_bf16 v[136:139], v[224:227], a[204:207], v[136:139]
buffer_load_dwordx4 a[196:199], v3, s[8:11], s31 offen offset:1024 sc1
v_mfma_f32_16x16x32_bf16 v[140:143], v[228:231], a[204:207], v[140:143]
v_exp_f32 v68, v68
v_mfma_f32_16x16x32_bf16 v[140:143], v[208:211], a[200:203], v[140:143]
v_exp_f32 v69, v69
v_mfma_f32_16x16x32_bf16 v[144:147], v[212:215], a[200:203], v[144:147]
v_exp_f32 v70, v70
v_mfma_f32_16x16x32_bf16 v[144:147], v[232:235], a[204:207], v[144:147]
ds_read_b128 a[228:231], v13 offset:1024
s_waitcnt vmcnt(12)
v_mfma_f32_16x16x32_bf16 v[148:151], v[196:199], a[208:211], v[148:151]
buffer_load_dwordx4 a[200:203], v3, s[8:11], s31 offen offset:2048 sc1
v_mfma_f32_16x16x32_bf16 v[148:151], v[216:219], a[212:215], v[148:151]
v_exp_f32 v71, v71
v_mfma_f32_16x16x32_bf16 v[152:155], v[220:223], a[212:215], v[152:155]
v_exp_f32 v72, v72
v_mfma_f32_16x16x32_bf16 v[152:155], v[200:203], a[208:211], v[152:155]
v_exp_f32 v73, v73
v_mfma_f32_16x16x32_bf16 v[156:159], v[204:207], a[208:211], v[156:159]
v_exp_f32 v74, v74
v_mfma_f32_16x16x32_bf16 v[156:159], v[224:227], a[212:215], v[156:159]
buffer_load_dwordx4 a[204:207], v3, s[8:11], s31 offen offset:3072 sc1
v_mfma_f32_16x16x32_bf16 v[160:163], v[228:231], a[212:215], v[160:163]
v_exp_f32 v75, v75
v_mfma_f32_16x16x32_bf16 v[160:163], v[208:211], a[208:211], v[160:163]
v_add_f32 v96, v96, v56
v_add_f32 v96, v96, v57
v_mfma_f32_16x16x32_bf16 v[164:167], v[212:215], a[208:211], v[164:167]
v_cvt_pk_bf16_f32 v78, v56, v57
v_add_f32 v96, v96, v58
v_mfma_f32_16x16x32_bf16 v[164:167], v[232:235], a[212:215], v[164:167]
ds_read_b128 a[232:235], v13 offset:2048
s_waitcnt vmcnt(12)
v_mfma_f32_16x16x32_bf16 v[168:171], v[196:199], a[216:219], v[168:171]
buffer_load_dwordx4 a[208:211], v4, s[8:11], s31 offen offset:0 sc1
v_mfma_f32_16x16x32_bf16 v[168:171], v[216:219], a[220:223], v[168:171]
ds_read_b128 a[236:239], v13 offset:3072
v_add_f32 v96, v96, v59
v_mfma_f32_16x16x32_bf16 v[172:175], v[220:223], a[220:223], v[172:175]
ds_read_b128 a[240:243], v13 offset:4096
v_cvt_pk_bf16_f32 v79, v58, v59
v_mfma_f32_16x16x32_bf16 v[172:175], v[200:203], a[216:219], v[172:175]
ds_read_b128 a[244:247], v13 offset:5120
v_add_f32 v97, v97, v60
v_mfma_f32_16x16x32_bf16 v[176:179], v[204:207], a[216:219], v[176:179]
ds_read_b128 a[248:251], v13 offset:6144
v_add_f32 v97, v97, v61
v_mfma_f32_16x16x32_bf16 v[176:179], v[224:227], a[220:223], v[176:179]
buffer_load_dwordx4 a[212:215], v4, s[8:11], s31 offen offset:1024 sc1
v_mfma_f32_16x16x32_bf16 v[180:183], v[228:231], a[220:223], v[180:183]
ds_read_b128 a[252:255], v13 offset:7168
v_cvt_pk_bf16_f32 v82, v60, v61
v_mfma_f32_16x16x32_bf16 v[180:183], v[208:211], a[216:219], v[180:183]
ds_read_b128 v[188:191], v13 offset:8192
v_add_f32 v97, v97, v62
v_mfma_f32_16x16x32_bf16 v[184:187], v[212:215], a[216:219], v[184:187]
v_add_f32 v97, v97, v63
v_cvt_pk_bf16_f32 v83, v62, v63
v_mfma_f32_16x16x32_bf16 v[184:187], v[232:235], a[220:223], v[184:187]
ds_read_b128 v[192:195], v13 offset:9216
s_waitcnt vmcnt(12)
s_cmp_lg_u32 s34, 0
s_cbranch_scc1 La_loop
La_tailcode:
s_add_u32 s33, s32, 16384
s_waitcnt lgkmcnt(0)
v_mfma_f32_16x16x32_bf16 v[108:111], a[224:227], a[160:163], v[108:111]
buffer_load_dwordx4 a[216:219], v4, s[8:11], s32 offen offset:2048 sc1
v_mfma_f32_16x16x32_bf16 v[108:111], a[244:247], a[164:167], v[108:111]
ds_read_b128 v[196:199], v13 offset:10240
ds_read_b128 v[200:203], v13 offset:11264
v_mfma_f32_16x16x32_bf16 v[112:115], a[248:251], a[164:167], v[112:115]
ds_read_b128 v[204:207], v13 offset:12288
ds_read_b128 v[208:211], v13 offset:13312
v_mfma_f32_16x16x32_bf16 v[112:115], a[228:231], a[160:163], v[112:115]
ds_read_b128 v[212:215], v13 offset:14336
ds_read_b128 v[216:219], v13 offset:15360
v_mfma_f32_16x16x32_bf16 v[116:119], a[232:235], a[160:163], v[116:119]
ds_read_b128 v[220:223], v13 offset:16384
ds_read_b128 v[224:227], v13 offset:17408
v_mfma_f32_16x16x32_bf16 v[116:119], a[252:255], a[164:167], v[116:119]
buffer_load_dwordx4 a[220:223], v4, s[8:11], s32 offen offset:3072 sc1
v_mfma_f32_16x16x32_bf16 v[120:123], v[188:191], a[164:167], v[120:123]
ds_read_b128 v[228:231], v13 offset:18432
ds_read_b128 v[232:235], v13 offset:19456
v_mfma_f32_16x16x32_bf16 v[120:123], a[236:239], a[160:163], v[120:123]
v_add_f32 v98, v98, v64
v_add_f32 v98, v98, v65
v_mfma_f32_16x16x32_bf16 v[124:127], a[240:243], a[160:163], v[124:127]
v_cvt_pk_bf16_f32 v86, v64, v65
v_add_f32 v98, v98, v66
buffer_load_dwordx4 v[36:39], v3, s[8:11], s33 offen offset:2048 sc1
v_mfma_f32_16x16x32_bf16 v[124:127], v[192:195], a[164:167], v[124:127]
v_add_f32 v98, v98, v67
s_waitcnt vmcnt(13)
v_mfma_f32_16x16x32_bf16 v[128:131], a[224:227], a[168:171], v[128:131]
buffer_load_dwordx4 a[160:163], v1, s[8:11], s33 offen offset:0 sc1
v_mfma_f32_16x16x32_bf16 v[128:131], a[244:247], a[172:175], v[128:131]
v_cvt_pk_bf16_f32 v87, v66, v67
v_add_f32 v99, v99, v68
v_mfma_f32_16x16x32_bf16 v[132:135], a[248:251], a[172:175], v[132:135]
v_add_f32 v99, v99, v69
v_cvt_pk_bf16_f32 v90, v68, v69
v_mfma_f32_16x16x32_bf16 v[132:135], a[228:231], a[168:171], v[132:135]
v_add_f32 v99, v99, v70
v_add_f32 v99, v99, v71
v_mfma_f32_16x16x32_bf16 v[136:139], a[232:235], a[168:171], v[136:139]
v_cvt_pk_bf16_f32 v91, v70, v71
v_add_f32 v100, v100, v72
v_mfma_f32_16x16x32_bf16 v[136:139], a[252:255], a[172:175], v[136:139]
buffer_load_dwordx4 a[164:167], v1, s[8:11], s33 offen offset:1024 sc1
v_mfma_f32_16x16x32_bf16 v[140:143], v[188:191], a[172:175], v[140:143]
v_add_f32 v100, v100, v73
v_cvt_pk_bf16_f32 v94, v72, v73
v_mfma_f32_16x16x32_bf16 v[140:143], a[236:239], a[168:171], v[140:143]
v_add_f32 v100, v100, v74
v_add_f32 v100, v100, v75
v_mfma_f32_16x16x32_bf16 v[144:147], a[240:243], a[168:171], v[144:147]
v_cvt_pk_bf16_f32 v95, v74, v75
ds_write_b64 v12, v[78:79] offset:8
buffer_load_dwordx4 v[40:43], v3, s[8:11], s33 offen offset:3072 sc1
v_mfma_f32_16x16x32_bf16 v[144:147], v[192:195], a[172:175], v[144:147]
ds_write_b64 v12, v[82:83] offset:1032
s_waitcnt vmcnt(14)
v_mfma_f32_16x16x32_bf16 v[148:151], a[224:227], a[176:179], v[148:151]
buffer_load_dwordx4 a[168:171], v1, s[8:11], s33 offen offset:2048 sc1
v_mfma_f32_16x16x32_bf16 v[148:151], a[244:247], a[180:183], v[148:151]
ds_write_b64 v12, v[86:87] offset:2056
ds_write_b64 v12, v[90:91] offset:3080
v_mfma_f32_16x16x32_bf16 v[152:155], a[248:251], a[180:183], v[152:155]
ds_write_b64 v12, v[94:95] offset:4104
v_mov_b32 v236, v96
v_mfma_f32_16x16x32_bf16 v[152:155], a[228:231], a[176:179], v[152:155]
v_mov_b32 v237, v97
v_mov_b32 v238, v98
v_mfma_f32_16x16x32_bf16 v[156:159], a[232:235], a[176:179], v[156:159]
v_mov_b32 v239, v99
v_mov_b32 v240, v100
v_mfma_f32_16x16x32_bf16 v[156:159], a[252:255], a[180:183], v[156:159]
buffer_load_dwordx4 a[172:175], v1, s[8:11], s33 offen offset:3072 sc1
v_mfma_f32_16x16x32_bf16 v[160:163], v[188:191], a[180:183], v[160:163]
v_mov_b32 v241, v240
s_nop 0
v_mfma_f32_16x16x32_bf16 v[160:163], a[236:239], a[176:179], v[160:163]
v_permlane16_swap_b32 v236, v237
v_permlane16_swap_b32 v238, v239
v_mfma_f32_16x16x32_bf16 v[164:167], a[240:243], a[176:179], v[164:167]
v_permlane16_swap_b32 v240, v241
v_add_f32 v236, v236, v237
buffer_load_dwordx4 v[44:47], v4, s[8:11], s33 offen offset:0 sc1
v_mfma_f32_16x16x32_bf16 v[164:167], v[192:195], a[180:183], v[164:167]
v_add_f32 v238, v238, v239
s_waitcnt vmcnt(15)
v_mfma_f32_16x16x32_bf16 v[168:171], a[224:227], a[184:187], v[168:171]
buffer_load_dwordx4 a[176:179], v2, s[8:11], s33 offen offset:0 sc1
v_mfma_f32_16x16x32_bf16 v[168:171], a[244:247], a[188:191], v[168:171]
v_add_f32 v240, v240, v241
v_mov_b32 v241, v240
v_mfma_f32_16x16x32_bf16 v[172:175], a[248:251], a[188:191], v[172:175]
s_nop 0
v_permlane32_swap_b32 v236, v238
v_mfma_f32_16x16x32_bf16 v[172:175], a[228:231], a[184:187], v[172:175]
v_permlane32_swap_b32 v240, v241
v_add_f32 v236, v236, v238
v_mfma_f32_16x16x32_bf16 v[176:179], a[232:235], a[184:187], v[176:179]
v_add_f32 v240, v240, v241
s_lshl_b32 s36, s64, 2
v_mfma_f32_16x16x32_bf16 v[176:179], a[252:255], a[188:191], v[176:179]
buffer_load_dwordx4 a[180:183], v2, s[8:11], s33 offen offset:1024 sc1
v_mfma_f32_16x16x32_bf16 v[180:183], v[188:191], a[188:191], v[180:183]
s_add_u32 s36, s36, 133120
v_add_u32 v11, s36, v0
v_mfma_f32_16x16x32_bf16 v[180:183], a[236:239], a[184:187], v[180:183]
ds_write_b32 v11, v236
v_and_b32 v11, 0xf0, v0
v_mfma_f32_16x16x32_bf16 v[184:187], a[240:243], a[184:187], v[184:187]
v_add_u32 v11, s36, v11
ds_write_b32 v11, v240 offset:1024
buffer_load_dwordx4 v[48:51], v4, s[8:11], s33 offen offset:1024 sc1
v_mfma_f32_16x16x32_bf16 v[184:187], v[192:195], a[188:191], v[184:187]
s_waitcnt vmcnt(16) lgkmcnt(0)
v_mfma_f32_16x16x32_bf16 v[108:111], v[196:199], a[192:195], v[108:111]
buffer_load_dwordx4 a[184:187], v2, s[8:11], s33 offen offset:2048 sc1
v_mfma_f32_16x16x32_bf16 v[108:111], v[216:219], a[196:199], v[108:111]
v_mfma_f32_16x16x32_bf16 v[112:115], v[220:223], a[196:199], v[112:115]
v_mfma_f32_16x16x32_bf16 v[112:115], v[200:203], a[192:195], v[112:115]
v_mfma_f32_16x16x32_bf16 v[116:119], v[204:207], a[192:195], v[116:119]
v_mfma_f32_16x16x32_bf16 v[116:119], v[224:227], a[196:199], v[116:119]
buffer_load_dwordx4 a[188:191], v2, s[8:11], s33 offen offset:3072 sc1
v_mfma_f32_16x16x32_bf16 v[120:123], v[228:231], a[196:199], v[120:123]
v_mfma_f32_16x16x32_bf16 v[120:123], v[208:211], a[192:195], v[120:123]
v_mfma_f32_16x16x32_bf16 v[124:127], v[212:215], a[192:195], v[124:127]
buffer_load_dwordx4 v[52:55], v4, s[8:11], s33 offen offset:2048 sc1
v_mfma_f32_16x16x32_bf16 v[124:127], v[232:235], a[196:199], v[124:127]
s_waitcnt vmcnt(17) lgkmcnt(0)
s_barrier
v_mfma_f32_16x16x32_bf16 v[128:131], v[196:199], a[200:203], v[128:131]
buffer_load_dwordx4 a[192:195], v3, s[8:11], s33 offen offset:0 sc1
v_mfma_f32_16x16x32_bf16 v[128:131], v[216:219], a[204:207], v[128:131]
v_add_u32 v11, 133120, v0
ds_read_b128 v[236:239], v11
v_mfma_f32_16x16x32_bf16 v[132:135], v[220:223], a[204:207], v[132:135]
v_and_b32 v11, 0xf0, v0
v_add_u32 v11, 134144, v11
v_mfma_f32_16x16x32_bf16 v[132:135], v[200:203], a[200:203], v[132:135]
ds_read_b128 v[240:243], v11
v_add_u32 v13, 0x8000, v13
v_mfma_f32_16x16x32_bf16 v[136:139], v[204:207], a[200:203], v[136:139]
v_and_b32 v13, 0x1ffff, v13
ds_read_b128 a[224:227], v13 offset:0
v_mfma_f32_16x16x32_bf16 v[136:139], v[224:227], a[204:207], v[136:139]
buffer_load_dwordx4 a[196:199], v3, s[8:11], s33 offen offset:1024 sc1
v_mfma_f32_16x16x32_bf16 v[140:143], v[228:231], a[204:207], v[140:143]
ds_read_b128 a[244:247], v13 offset:5120
ds_read_b128 a[228:231], v13 offset:1024
v_mfma_f32_16x16x32_bf16 v[140:143], v[208:211], a[200:203], v[140:143]
ds_read_b128 a[248:251], v13 offset:6144
ds_read_b128 a[232:235], v13 offset:2048
v_mfma_f32_16x16x32_bf16 v[144:147], v[212:215], a[200:203], v[144:147]
ds_read_b128 a[252:255], v13 offset:7168
ds_read_b128 a[236:239], v13 offset:3072
buffer_load_dwordx4 v[248:251], v4, s[8:11], s33 offen offset:3072 sc1
v_mfma_f32_16x16x32_bf16 v[144:147], v[232:235], a[204:207], v[144:147]
ds_read_b128 v[188:191], v13 offset:8192
s_waitcnt vmcnt(18)
v_mfma_f32_16x16x32_bf16 v[148:151], v[196:199], a[208:211], v[148:151]
v_mfma_f32_16x16x32_bf16 v[148:151], v[216:219], a[212:215], v[148:151]
ds_read_b128 a[240:243], v13 offset:4096
ds_read_b128 v[192:195], v13 offset:9216
v_mfma_f32_16x16x32_bf16 v[152:155], v[220:223], a[212:215], v[152:155]
v_lshlrev_b32 v8, 11, v14
v_lshl_add_u32 v8, v15, 3, v8
v_mfma_f32_16x16x32_bf16 v[152:155], v[200:203], a[208:211], v[152:155]
s_lshl_b32 s46, s29, 9
s_add_u32 s46, s46, s39
v_mfma_f32_16x16x32_bf16 v[156:159], v[204:207], a[208:211], v[156:159]
s_lshl_b32 s47, s64, 7
s_add_u32 s46, s46, s47
v_mfma_f32_16x16x32_bf16 v[156:159], v[224:227], a[212:215], v[156:159]
v_mfma_f32_16x16x32_bf16 v[160:163], v[228:231], a[212:215], v[160:163]
v_mfma_f32_16x16x32_bf16 v[160:163], v[208:211], a[208:211], v[160:163]
v_mfma_f32_16x16x32_bf16 v[164:167], v[212:215], a[208:211], v[164:167]
v_mfma_f32_16x16x32_bf16 v[164:167], v[232:235], a[212:215], v[164:167]
s_waitcnt vmcnt(16) lgkmcnt(0)
v_mfma_f32_16x16x32_bf16 v[168:171], v[196:199], a[216:219], v[168:171]
v_add_f32 v236, v236, v237
v_add_f32 v238, v238, v239
v_mfma_f32_16x16x32_bf16 v[168:171], v[216:219], a[220:223], v[168:171]
v_add_f32 v240, v240, v241
v_add_f32 v242, v242, v243
v_mfma_f32_16x16x32_bf16 v[172:175], v[220:223], a[220:223], v[172:175]
v_add_f32 v236, v236, v238
v_add_f32 v240, v240, v242
v_mfma_f32_16x16x32_bf16 v[172:175], v[200:203], a[216:219], v[172:175]
s_lshl_b32 s36, s64, 9
v_rcp_f32 v244, v236
v_mfma_f32_16x16x32_bf16 v[176:179], v[204:207], a[216:219], v[176:179]
v_rcp_f32 v245, v240
s_add_u32 s36, s36, 135168
v_mfma_f32_16x16x32_bf16 v[176:179], v[224:227], a[220:223], v[176:179]
v_lshrrev_b32 v11, 2, v0
v_add_u32 v11, s36, v11
v_mfma_f32_16x16x32_bf16 v[180:183], v[228:231], a[220:223], v[180:183]
ds_write_b32 v11, v244
v_bfe_u32 v11, v0, 2, 6
v_mfma_f32_16x16x32_bf16 v[180:183], v[208:211], a[216:219], v[180:183]
v_add_u32 v11, s36, v11
ds_write_b32 v11, v245 offset:256
v_mfma_f32_16x16x32_bf16 v[184:187], v[212:215], a[216:219], v[184:187]
v_mfma_f32_16x16x32_bf16 v[184:187], v[232:235], a[220:223], v[184:187]
s_waitcnt vmcnt(13)
v_mfma_f32_16x16x32_bf16 v[108:111], a[224:227], a[160:163], v[108:111]
ds_read_b128 v[196:199], v13 offset:10240
ds_read_b128 v[216:219], v13 offset:15360
v_mfma_f32_16x16x32_bf16 v[108:111], a[244:247], a[164:167], v[108:111]
v_lshrrev_b32 v11, 4, v0
s_waitcnt vmcnt(10)
v_mfma_f32_16x16x32_bf16 v[128:131], a[224:227], a[168:171], v[128:131]
v_and_b32 v11, 0x30, v11
v_add_u32 v11, s36, v11
v_mfma_f32_16x16x32_bf16 v[128:131], a[244:247], a[172:175], v[128:131]
ds_read_b128 v[16:19], v11 offset:0
s_waitcnt vmcnt(7)
v_mfma_f32_16x16x32_bf16 v[148:151], a[224:227], a[176:179], v[148:151]
ds_read_b128 v[20:23], v11 offset:64
ds_read_b128 v[24:27], v11 offset:128
v_mfma_f32_16x16x32_bf16 v[148:151], a[244:247], a[180:183], v[148:151]
ds_read_b128 v[28:31], v11 offset:192
s_waitcnt vmcnt(4)
v_mfma_f32_16x16x32_bf16 v[168:171], a[224:227], a[184:187], v[168:171]
ds_read_b128 v[32:35], v11 offset:256
v_max_f32 v237, v236, v240
v_mfma_f32_16x16x32_bf16 v[168:171], a[244:247], a[188:191], v[168:171]
v_min_f32 v238, v236, v240
s_waitcnt vmcnt(1) lgkmcnt(5)
v_mfma_f32_16x16x32_bf16 v[108:111], v[196:199], a[192:195], v[108:111]
v_add_f32 v239, v236, v240
s_mov_b32 s40, 0x4f800000
v_mfma_f32_16x16x32_bf16 v[108:111], v[216:219], a[196:199], v[108:111]
s_mov_b32 s41, 0x2b800000
s_waitcnt vmcnt(12)
v_mfma_f32_16x16x32_bf16 v[128:131], v[196:199], v[36:39], v[128:131]
v_cmp_nge_f32 vcc, s40, v237
v_cmp_gt_f32 s[42:43], s41, v238
v_mfma_f32_16x16x32_bf16 v[128:131], v[216:219], v[40:43], v[128:131]
v_cmp_u_f32 s[44:45], v239, v239
s_waitcnt vmcnt(6)
v_mfma_f32_16x16x32_bf16 v[148:151], v[196:199], v[44:47], v[148:151]
s_or_b64 s[42:43], vcc, s[42:43]
s_nop 0
v_mfma_f32_16x16x32_bf16 v[148:151], v[216:219], v[48:51], v[148:151]
s_or_b64 s[42:43], s[42:43], s[44:45]
s_waitcnt vmcnt(0)
v_mfma_f32_16x16x32_bf16 v[168:171], v[196:199], v[52:55], v[168:171]
ds_read_b128 v[200:203], v13 offset:11264
ds_read_b128 v[220:223], v13 offset:16384
v_mfma_f32_16x16x32_bf16 v[168:171], v[216:219], v[248:251], v[168:171]
ds_read_b128 v[204:207], v13 offset:12288
ds_read_b128 v[224:227], v13 offset:17408
v_mfma_f32_16x16x32_bf16 v[112:115], a[228:231], a[160:163], v[112:115]
ds_read_b128 v[208:211], v13 offset:13312
ds_read_b128 v[228:231], v13 offset:18432
v_mfma_f32_16x16x32_bf16 v[112:115], a[248:251], a[164:167], v[112:115]
ds_read_b128 v[212:215], v13 offset:14336
ds_read_b128 v[232:235], v13 offset:19456
v_mfma_f32_16x16x32_bf16 v[132:135], a[228:231], a[168:171], v[132:135]
v_mfma_f32_16x16x32_bf16 v[132:135], a[248:251], a[172:175], v[132:135]
v_mfma_f32_16x16x32_bf16 v[152:155], a[228:231], a[176:179], v[152:155]
v_mfma_f32_16x16x32_bf16 v[152:155], a[248:251], a[180:183], v[152:155]
s_waitcnt lgkmcnt(0)
s_cmp_lg_u32 s35, 0
s_cbranch_scc1 La_store
s_cmp_lg_u64 s[42:43], 0
s_cbranch_scc1 La_fallback
La_store:
s_cmp_eq_u32 s30, 0
s_cselect_b32 s26, s26, 0
v_mfma_f32_16x16x32_bf16 v[172:175], a[228:231], a[184:187], v[172:175]
v_mul_f32 v56, v108, v16
v_mul_f32 v57, v128, v16
v_mfma_f32_16x16x32_bf16 v[172:175], a[248:251], a[188:191], v[172:175]
v_mul_f32 v58, v148, v16
v_mul_f32 v59, v168, v16
v_mfma_f32_16x16x32_bf16 v[112:115], v[200:203], a[192:195], v[112:115]
v_cvt_pk_bf16_f32 v60, v56, v57
v_cvt_pk_bf16_f32 v61, v58, v59
v_mfma_f32_16x16x32_bf16 v[112:115], v[220:223], a[196:199], v[112:115]
buffer_store_dwordx2 v[60:61], v8, s[24:27], s46 offen offset:0 sc1 nt
v_mfma_f32_16x16x32_bf16 v[132:135], v[200:203], v[36:39], v[132:135]
v_mul_f32 v64, v109, v17
v_mul_f32 v65, v129, v17
v_mfma_f32_16x16x32_bf16 v[132:135], v[220:223], v[40:43], v[132:135]
v_mul_f32 v66, v149, v17
v_mul_f32 v67, v169, v17
v_mfma_f32_16x16x32_bf16 v[152:155], v[200:203], v[44:47], v[152:155]
v_cvt_pk_bf16_f32 v68, v64, v65
v_cvt_pk_bf16_f32 v69, v66, v67
v_mfma_f32_16x16x32_bf16 v[152:155], v[220:223], v[48:51], v[152:155]
buffer_store_dwordx2 v[68:69], v8, s[24:27], s46 offen offset:512 sc1 nt
v_mfma_f32_16x16x32_bf16 v[172:175], v[200:203], v[52:55], v[172:175]
v_mul_f32 v56, v110, v18
v_mul_f32 v57, v130, v18
v_mfma_f32_16x16x32_bf16 v[172:175], v[220:223], v[248:251], v[172:175]
v_mul_f32 v58, v150, v18
v_mul_f32 v59, v170, v18
v_mfma_f32_16x16x32_bf16 v[116:119], a[232:235], a[160:163], v[116:119]
v_cvt_pk_bf16_f32 v60, v56, v57
v_cvt_pk_bf16_f32 v61, v58, v59
v_mfma_f32_16x16x32_bf16 v[116:119], a[252:255], a[164:167], v[116:119]
buffer_store_dwordx2 v[60:61], v8, s[24:27], s46 offen offset:1024 sc1 nt
v_mfma_f32_16x16x32_bf16 v[136:139], a[232:235], a[168:171], v[136:139]
v_mul_f32 v64, v111, v19
v_mul_f32 v65, v131, v19
v_mfma_f32_16x16x32_bf16 v[136:139], a[252:255], a[172:175], v[136:139]
v_mul_f32 v66, v151, v19
v_mul_f32 v67, v171, v19
v_mfma_f32_16x16x32_bf16 v[156:159], a[232:235], a[176:179], v[156:159]
v_cvt_pk_bf16_f32 v68, v64, v65
v_cvt_pk_bf16_f32 v69, v66, v67
v_mfma_f32_16x16x32_bf16 v[156:159], a[252:255], a[180:183], v[156:159]
buffer_store_dwordx2 v[68:69], v8, s[24:27], s46 offen offset:1536 sc1 nt
v_mfma_f32_16x16x32_bf16 v[176:179], a[232:235], a[184:187], v[176:179]
s_add_u32 s46, s46, 8192
v_mul_f32 v72, v112, v20
v_mfma_f32_16x16x32_bf16 v[176:179], a[252:255], a[188:191], v[176:179]
v_mul_f32 v73, v132, v20
v_mul_f32 v74, v152, v20
v_mfma_f32_16x16x32_bf16 v[116:119], v[204:207], a[192:195], v[116:119]
v_mul_f32 v75, v172, v20
v_cvt_pk_bf16_f32 v76, v72, v73
v_mfma_f32_16x16x32_bf16 v[116:119], v[224:227], a[196:199], v[116:119]
v_cvt_pk_bf16_f32 v77, v74, v75
v_mfma_f32_16x16x32_bf16 v[136:139], v[204:207], v[36:39], v[136:139]
buffer_store_dwordx2 v[76:77], v8, s[24:27], s46 offen offset:0 sc1 nt
v_mfma_f32_16x16x32_bf16 v[136:139], v[224:227], v[40:43], v[136:139]
v_mul_f32 v80, v113, v21
v_mul_f32 v81, v133, v21
v_mfma_f32_16x16x32_bf16 v[156:159], v[204:207], v[44:47], v[156:159]
v_mul_f32 v82, v153, v21
v_mul_f32 v83, v173, v21
v_mfma_f32_16x16x32_bf16 v[156:159], v[224:227], v[48:51], v[156:159]
v_cvt_pk_bf16_f32 v84, v80, v81
v_cvt_pk_bf16_f32 v85, v82, v83
v_mfma_f32_16x16x32_bf16 v[176:179], v[204:207], v[52:55], v[176:179]
buffer_store_dwordx2 v[84:85], v8, s[24:27], s46 offen offset:512 sc1 nt
v_mfma_f32_16x16x32_bf16 v[176:179], v[224:227], v[248:251], v[176:179]
v_mul_f32 v72, v114, v22
v_mul_f32 v73, v134, v22
v_mfma_f32_16x16x32_bf16 v[120:123], a[236:239], a[160:163], v[120:123]
v_mul_f32 v74, v154, v22
v_mul_f32 v75, v174, v22
v_mfma_f32_16x16x32_bf16 v[120:123], v[188:191], a[164:167], v[120:123]
v_cvt_pk_bf16_f32 v76, v72, v73
v_cvt_pk_bf16_f32 v77, v74, v75
v_mfma_f32_16x16x32_bf16 v[140:143], a[236:239], a[168:171], v[140:143]
buffer_store_dwordx2 v[76:77], v8, s[24:27], s46 offen offset:1024 sc1 nt
v_mfma_f32_16x16x32_bf16 v[140:143], v[188:191], a[172:175], v[140:143]
v_mul_f32 v80, v115, v23
v_mul_f32 v81, v135, v23
v_mfma_f32_16x16x32_bf16 v[160:163], a[236:239], a[176:179], v[160:163]
v_mul_f32 v82, v155, v23
v_mul_f32 v83, v175, v23
v_mfma_f32_16x16x32_bf16 v[160:163], v[188:191], a[180:183], v[160:163]
v_cvt_pk_bf16_f32 v84, v80, v81
v_cvt_pk_bf16_f32 v85, v82, v83
v_mfma_f32_16x16x32_bf16 v[180:183], a[236:239], a[184:187], v[180:183]
buffer_store_dwordx2 v[84:85], v8, s[24:27], s46 offen offset:1536 sc1 nt
v_mfma_f32_16x16x32_bf16 v[180:183], v[188:191], a[188:191], v[180:183]
s_add_u32 s46, s46, 8192
s_mov_b32 s26, 8388608
v_mfma_f32_16x16x32_bf16 v[120:123], v[208:211], a[192:195], v[120:123]
v_mul_f32 v56, v116, v24
v_mul_f32 v57, v136, v24
v_mfma_f32_16x16x32_bf16 v[120:123], v[228:231], a[196:199], v[120:123]
v_mul_f32 v58, v156, v24
v_mul_f32 v59, v176, v24
v_mfma_f32_16x16x32_bf16 v[140:143], v[208:211], v[36:39], v[140:143]
v_cvt_pk_bf16_f32 v60, v56, v57
v_cvt_pk_bf16_f32 v61, v58, v59
v_mfma_f32_16x16x32_bf16 v[140:143], v[228:231], v[40:43], v[140:143]
buffer_store_dwordx2 v[60:61], v8, s[24:27], s46 offen offset:0 sc1 nt
v_mfma_f32_16x16x32_bf16 v[160:163], v[208:211], v[44:47], v[160:163]
v_mul_f32 v64, v117, v25
v_mul_f32 v65, v137, v25
v_mfma_f32_16x16x32_bf16 v[160:163], v[228:231], v[48:51], v[160:163]
v_mul_f32 v66, v157, v25
v_mul_f32 v67, v177, v25
v_mfma_f32_16x16x32_bf16 v[180:183], v[208:211], v[52:55], v[180:183]
v_cvt_pk_bf16_f32 v68, v64, v65
v_cvt_pk_bf16_f32 v69, v66, v67
v_mfma_f32_16x16x32_bf16 v[180:183], v[228:231], v[248:251], v[180:183]
buffer_store_dwordx2 v[68:69], v8, s[24:27], s46 offen offset:512 sc1 nt
v_mfma_f32_16x16x32_bf16 v[124:127], a[240:243], a[160:163], v[124:127]
v_mul_f32 v56, v118, v26
v_mul_f32 v57, v138, v26
v_mfma_f32_16x16x32_bf16 v[124:127], v[192:195], a[164:167], v[124:127]
v_mul_f32 v58, v158, v26
v_mul_f32 v59, v178, v26
v_mfma_f32_16x16x32_bf16 v[144:147], a[240:243], a[168:171], v[144:147]
v_cvt_pk_bf16_f32 v60, v56, v57
v_cvt_pk_bf16_f32 v61, v58, v59
v_mfma_f32_16x16x32_bf16 v[144:147], v[192:195], a[172:175], v[144:147]
buffer_store_dwordx2 v[60:61], v8, s[24:27], s46 offen offset:1024 sc1 nt
v_mfma_f32_16x16x32_bf16 v[164:167], a[240:243], a[176:179], v[164:167]
v_mul_f32 v64, v119, v27
v_mul_f32 v65, v139, v27
v_mfma_f32_16x16x32_bf16 v[164:167], v[192:195], a[180:183], v[164:167]
v_mul_f32 v66, v159, v27
v_mul_f32 v67, v179, v27
v_mfma_f32_16x16x32_bf16 v[184:187], a[240:243], a[184:187], v[184:187]
v_cvt_pk_bf16_f32 v68, v64, v65
v_cvt_pk_bf16_f32 v69, v66, v67
v_mfma_f32_16x16x32_bf16 v[184:187], v[192:195], a[188:191], v[184:187]
buffer_store_dwordx2 v[68:69], v8, s[24:27], s46 offen offset:1536 sc1 nt
v_mfma_f32_16x16x32_bf16 v[124:127], v[212:215], a[192:195], v[124:127]
s_add_u32 s46, s46, 8192
v_mul_f32 v72, v120, v28
v_mfma_f32_16x16x32_bf16 v[124:127], v[232:235], a[196:199], v[124:127]
v_mul_f32 v73, v140, v28
v_mul_f32 v74, v160, v28
v_mfma_f32_16x16x32_bf16 v[144:147], v[212:215], v[36:39], v[144:147]
v_mul_f32 v75, v180, v28
v_cvt_pk_bf16_f32 v76, v72, v73
v_mfma_f32_16x16x32_bf16 v[144:147], v[232:235], v[40:43], v[144:147]
v_cvt_pk_bf16_f32 v77, v74, v75
v_mfma_f32_16x16x32_bf16 v[164:167], v[212:215], v[44:47], v[164:167]
buffer_store_dwordx2 v[76:77], v8, s[24:27], s46 offen offset:0 sc1 nt
v_mfma_f32_16x16x32_bf16 v[164:167], v[232:235], v[48:51], v[164:167]
v_mul_f32 v80, v121, v29
v_mul_f32 v81, v141, v29
v_mfma_f32_16x16x32_bf16 v[184:187], v[212:215], v[52:55], v[184:187]
v_mul_f32 v82, v161, v29
v_mul_f32 v83, v181, v29
v_mfma_f32_16x16x32_bf16 v[184:187], v[232:235], v[248:251], v[184:187]
v_cvt_pk_bf16_f32 v84, v80, v81
v_cvt_pk_bf16_f32 v85, v82, v83
buffer_store_dwordx2 v[84:85], v8, s[24:27], s46 offen offset:512 sc1 nt
v_mul_f32 v72, v122, v30
v_mul_f32 v73, v142, v30
v_mul_f32 v74, v162, v30
v_mul_f32 v75, v182, v30
v_cvt_pk_bf16_f32 v76, v72, v73
v_cvt_pk_bf16_f32 v77, v74, v75
buffer_store_dwordx2 v[76:77], v8, s[24:27], s46 offen offset:1024 sc1 nt
v_mul_f32 v80, v123, v31
v_mul_f32 v81, v143, v31
v_mul_f32 v82, v163, v31
v_mul_f32 v83, v183, v31
v_cvt_pk_bf16_f32 v84, v80, v81
v_cvt_pk_bf16_f32 v85, v82, v83
buffer_store_dwordx2 v[84:85], v8, s[24:27], s46 offen offset:1536 sc1 nt
s_add_u32 s46, s46, 8192
v_mul_f32 v56, v124, v32
v_mul_f32 v57, v144, v32
v_mul_f32 v58, v164, v32
v_mul_f32 v59, v184, v32
v_cvt_pk_bf16_f32 v60, v56, v57
v_cvt_pk_bf16_f32 v61, v58, v59
buffer_store_dwordx2 v[60:61], v8, s[24:27], s46 offen offset:0 sc1 nt
v_mul_f32 v64, v125, v33
v_mul_f32 v65, v145, v33
v_mul_f32 v66, v165, v33
v_mul_f32 v67, v185, v33
v_cvt_pk_bf16_f32 v68, v64, v65
v_cvt_pk_bf16_f32 v69, v66, v67
buffer_store_dwordx2 v[68:69], v8, s[24:27], s46 offen offset:512 sc1 nt
v_mul_f32 v56, v126, v34
v_mul_f32 v57, v146, v34
v_mul_f32 v58, v166, v34
v_mul_f32 v59, v186, v34
v_cvt_pk_bf16_f32 v60, v56, v57
v_cvt_pk_bf16_f32 v61, v58, v59
buffer_store_dwordx2 v[60:61], v8, s[24:27], s46 offen offset:1024 sc1 nt
v_mul_f32 v64, v127, v35
v_mul_f32 v65, v147, v35
v_mul_f32 v66, v167, v35
v_mul_f32 v67, v187, v35
v_cvt_pk_bf16_f32 v68, v64, v65
v_cvt_pk_bf16_f32 v69, v66, v67
buffer_store_dwordx2 v[68:69], v8, s[24:27], s46 offen offset:1536 sc1 nt
La_done:
s_endpgm
La_late:
s_mov_b32 s36, 0x20000
s_waitcnt vmcnt(0)
La_w2:
v_cmp_ne_u32 vcc, s65, v6
s_sub_u32 s36, s36, 1
s_cbranch_scc1 La_w2_ok
s_and_b64 s[44:45], vcc, s[42:43]
s_cbranch_scc0 La_w2_ok
s_sleep 3
buffer_load_dword v6, v5, s[8:11], 0 offen sc1
s_waitcnt vmcnt(0)
s_branch La_w2
La_w2_ok:
s_branch La_cont
La_fallback:
s_mov_b32 s35, 1
s_mov_b32 s31, 0
s_mov_b32 s34, 32
La_fb_loop:
buffer_load_dwordx4 a[160:163], v1, s[8:11], s31 offen offset:0 sc1
buffer_load_dwordx4 a[164:167], v1, s[8:11], s31 offen offset:1024 sc1
buffer_load_dwordx4 a[168:171], v1, s[8:11], s31 offen offset:2048 sc1
buffer_load_dwordx4 a[172:175], v1, s[8:11], s31 offen offset:3072 sc1
buffer_load_dwordx4 a[176:179], v2, s[8:11], s31 offen offset:0 sc1
buffer_load_dwordx4 a[180:183], v2, s[8:11], s31 offen offset:1024 sc1
buffer_load_dwordx4 a[184:187], v2, s[8:11], s31 offen offset:2048 sc1
buffer_load_dwordx4 a[188:191], v2, s[8:11], s31 offen offset:3072 sc1
s_waitcnt vmcnt(0)
v_mfma_f32_16x16x32_bf16 v[36:39], a[160:163], a[0:3], 0
v_mfma_f32_16x16x32_bf16 v[40:43], a[160:163], a[32:35], 0
v_mfma_f32_16x16x32_bf16 v[44:47], a[160:163], a[64:67], 0
v_mfma_f32_16x16x32_bf16 v[48:51], a[160:163], a[96:99], 0
v_mfma_f32_16x16x32_bf16 v[52:55], a[160:163], a[128:131], 0
v_mfma_f32_16x16x32_bf16 v[36:39], a[164:167], a[4:7], v[36:39]
v_mfma_f32_16x16x32_bf16 v[40:43], a[164:167], a[36:39], v[40:43]
v_mfma_f32_16x16x32_bf16 v[44:47], a[164:167], a[68:71], v[44:47]
v_mfma_f32_16x16x32_bf16 v[48:51], a[164:167], a[100:103], v[48:51]
v_mfma_f32_16x16x32_bf16 v[52:55], a[164:167], a[132:135], v[52:55]
v_mfma_f32_16x16x32_bf16 v[36:39], a[168:171], a[8:11], v[36:39]
v_mfma_f32_16x16x32_bf16 v[40:43], a[168:171], a[40:43], v[40:43]
v_mfma_f32_16x16x32_bf16 v[44:47], a[168:171], a[72:75], v[44:47]
v_mfma_f32_16x16x32_bf16 v[48:51], a[168:171], a[104:107], v[48:51]
v_mfma_f32_16x16x32_bf16 v[52:55], a[168:171], a[136:139], v[52:55]
v_mfma_f32_16x16x32_bf16 v[36:39], a[172:175], a[12:15], v[36:39]
v_mfma_f32_16x16x32_bf16 v[40:43], a[172:175], a[44:47], v[40:43]
v_mfma_f32_16x16x32_bf16 v[44:47], a[172:175], a[76:79], v[44:47]
v_mfma_f32_16x16x32_bf16 v[48:51], a[172:175], a[108:111], v[48:51]
v_mfma_f32_16x16x32_bf16 v[52:55], a[172:175], a[140:143], v[52:55]
v_mfma_f32_16x16x32_bf16 v[36:39], a[176:179], a[16:19], v[36:39]
v_mfma_f32_16x16x32_bf16 v[40:43], a[176:179], a[48:51], v[40:43]
v_mfma_f32_16x16x32_bf16 v[44:47], a[176:179], a[80:83], v[44:47]
v_mfma_f32_16x16x32_bf16 v[48:51], a[176:179], a[112:115], v[48:51]
v_mfma_f32_16x16x32_bf16 v[52:55], a[176:179], a[144:147], v[52:55]
v_mfma_f32_16x16x32_bf16 v[36:39], a[180:183], a[20:23], v[36:39]
v_mfma_f32_16x16x32_bf16 v[40:43], a[180:183], a[52:55], v[40:43]
v_mfma_f32_16x16x32_bf16 v[44:47], a[180:183], a[84:87], v[44:47]
v_mfma_f32_16x16x32_bf16 v[48:51], a[180:183], a[116:119], v[48:51]
v_mfma_f32_16x16x32_bf16 v[52:55], a[180:183], a[148:151], v[52:55]
v_mfma_f32_16x16x32_bf16 v[36:39], a[184:187], a[24:27], v[36:39]
v_mfma_f32_16x16x32_bf16 v[40:43], a[184:187], a[56:59], v[40:43]
v_mfma_f32_16x16x32_bf16 v[44:47], a[184:187], a[88:91], v[44:47]
v_mfma_f32_16x16x32_bf16 v[48:51], a[184:187], a[120:123], v[48:51]
v_mfma_f32_16x16x32_bf16 v[52:55], a[184:187], a[152:155], v[52:55]
v_mfma_f32_16x16x32_bf16 v[36:39], a[188:191], a[28:31], v[36:39]
v_mfma_f32_16x16x32_bf16 v[40:43], a[188:191], a[60:63], v[40:43]
v_mfma_f32_16x16x32_bf16 v[44:47], a[188:191], a[92:95], v[44:47]
v_mfma_f32_16x16x32_bf16 v[48:51], a[188:191], a[124:127], v[48:51]
v_mfma_f32_16x16x32_bf16 v[52:55], a[188:191], a[156:159], v[52:55]
s_add_u32 s31, s31, 8192
s_sub_u32 s34, s34, 1
s_nop 7
v_max3_f32 v101, v36, v37, v101
v_max3_f32 v101, v38, v39, v101
v_max3_f32 v102, v40, v41, v102
v_max3_f32 v102, v42, v43, v102
v_max3_f32 v103, v44, v45, v103
v_max3_f32 v103, v46, v47, v103
v_max3_f32 v104, v48, v49, v104
v_max3_f32 v104, v50, v51, v104
v_max3_f32 v105, v52, v53, v105
v_max3_f32 v105, v54, v55, v105
s_cmp_lg_u32 s34, 0
s_cbranch_scc1 La_fb_loop
v_mov_b32 v106, v105
s_nop 0
v_permlane16_swap_b32 v101, v102
v_permlane16_swap_b32 v103, v104
v_permlane16_swap_b32 v105, v106
v_max_f32 v101, v101, v102
v_max_f32 v103, v103, v104
v_max_f32 v105, v105, v106
v_mov_b32 v106, v105
s_nop 0
v_permlane32_swap_b32 v101, v103
v_permlane32_swap_b32 v105, v106
v_max_f32 v101, v101, v103
v_max_f32 v105, v105, v106
s_lshl_b32 s36, s64, 2
s_add_u32 s36, s36, 131072
v_add_u32 v11, s36, v0
ds_write_b32 v11, v101
v_and_b32 v11, 0xf0, v0
v_add_u32 v11, s36, v11
ds_write_b32 v11, v105 offset:1024
v_and_b32 v11, 0xf0, v0
v_add_u32 v11, 131072, v11
s_waitcnt lgkmcnt(0)
s_barrier
ds_read_b128 v[16:19], v11 offset:0
ds_read_b128 v[20:23], v11 offset:256
ds_read_b128 v[24:27], v11 offset:512
ds_read_b128 v[28:31], v11 offset:768
ds_read_b128 v[32:35], v11 offset:1024
s_waitcnt lgkmcnt(4)
v_max3_f32 v16, v16, v17, v18
v_max_f32 v16, v16, v19
v_sub_f32 v16, 0, v16
v_mov_b32 v17, v16
v_mov_b32 v18, v16
v_mov_b32 v19, v16
s_waitcnt lgkmcnt(3)
v_max3_f32 v20, v20, v21, v22
v_max_f32 v20, v20, v23
v_sub_f32 v20, 0, v20
v_mov_b32 v21, v20
v_mov_b32 v22, v20
v_mov_b32 v23, v20
s_waitcnt lgkmcnt(2)
v_max3_f32 v24, v24, v25, v26
v_max_f32 v24, v24, v27
v_sub_f32 v24, 0, v24
v_mov_b32 v25, v24
v_mov_b32 v26, v24
v_mov_b32 v27, v24
s_waitcnt lgkmcnt(1)
v_max3_f32 v28, v28, v29, v30
v_max_f32 v28, v28, v31
v_sub_f32 v28, 0, v28
v_mov_b32 v29, v28
v_mov_b32 v30, v28
v_mov_b32 v31, v28
s_waitcnt lgkmcnt(0)
v_max3_f32 v32, v32, v33, v34
v_max_f32 v32, v32, v35
v_sub_f32 v32, 0, v32
v_mov_b32 v33, v32
v_mov_b32 v34, v32
v_mov_b32 v35, v32
v_bfe_u32 v8, v0, 4, 3
v_lshlrev_b32 v8, 5, v8
s_lshl_b32 s36, s28, 12
s_add_u32 s36, s36, 16908288
v_add_u32 v8, s36, v8
s_mov_b32 s31, 0
s_mov_b32 s32, 8388608
buffer_load_dwordx4 a[160:163], v1, s[8:11], s31 offen offset:0 sc1
buffer_load_dwordx4 a[164:167], v1, s[8:11], s31 offen offset:1024 sc1
buffer_load_dwordx4 a[168:171], v1, s[8:11], s31 offen offset:2048 sc1
buffer_load_dwordx4 a[172:175], v1, s[8:11], s31 offen offset:3072 sc1
buffer_load_dwordx4 a[176:179], v2, s[8:11], s31 offen offset:0 sc1
buffer_load_dwordx4 a[180:183], v2, s[8:11], s31 offen offset:1024 sc1
buffer_load_dwordx4 a[184:187], v2, s[8:11], s31 offen offset:2048 sc1
buffer_load_dwordx4 a[188:191], v2, s[8:11], s31 offen offset:3072 sc1
buffer_load_dwordx4 a[192:195], v3, s[8:11], s31 offen offset:0 sc1
buffer_load_dwordx4 a[196:199], v3, s[8:11], s31 offen offset:1024 sc1
buffer_load_dwordx4 a[200:203], v3, s[8:11], s31 offen offset:2048 sc1
buffer_load_dwordx4 a[204:207], v3, s[8:11], s31 offen offset:3072 sc1
buffer_load_dwordx4 a[208:211], v4, s[8:11], s31 offen offset:0 sc1
buffer_load_dwordx4 a[212:215], v4, s[8:11], s31 offen offset:1024 sc1
buffer_load_dwordx4 a[216:219], v4, s[8:11], s31 offen offset:2048 sc1
buffer_load_dwordx4 a[220:223], v4, s[8:11], s31 offen offset:3072 sc1
s_add_u32 s31, s31, 16384
s_branch La_restart
La_end:
.section .rodata,"a"
.p2align 6
.amdhsa_kernel standalone__kv_cache_quant_pre_rope_vs_post_rope__prompt_kernel
  .amdhsa_next_free_vgpr 512
  .amdhsa_next_free_sgpr 102
  .amdhsa_accum_offset 256
  .amdhsa_group_segment_fixed_size 0
  .amdhsa_kernarg_size 112
  .amdhsa_user_sgpr_count 2
  .amdhsa_user_sgpr_kernarg_segment_ptr 1
  .amdhsa_system_sgpr_workgroup_id_x 1
.end_amdhsa_kernel
```
